```python
import torch

def _softmax(x, axis=-1):
    return torch.softmax(x, dim=axis)
def _gelu(x):
    return torch.nn.functional.gelu(x, approximate="tanh")
def _silu(x):
    return torch.nn.functional.silu(x)
def _sigmoid(x):
    return torch.sigmoid(x)
def _layernorm(x, axis=-1, eps=1e-5):
    m = x.mean(dim=axis, keepdim=True)
    v = x.var(dim=axis, keepdim=True, unbiased=False)
    return (x - m) / torch.sqrt(v + eps)
def _scatter_add(tgt, idx, src, axis=0):
    return tgt.clone().index_add_(axis, idx, src)
def _segment_sum(src, seg, n):
    out = torch.zeros((n,) + src.shape[1:], dtype=src.dtype)
    return out.index_add_(0, seg, src)
def _pad(x, pw):
    flat = tuple(v for pair in reversed(pw) for v in pair)
    return torch.nn.functional.pad(x, flat)

kernel_name = 'gated_mix__sliding_block_cached__swiglu_ffn__decode'

def setup_inputs():

    _w = (lambda a: (lambda t: t.to(torch.bfloat16) if t.is_floating_point() else t)(torch.as_tensor(a)))
    def _A_setup():
        B, Sq, D = 2, 1, 512
        Hq, Hkv, Sk, Dh = 32, 8, 32768, 128
        assert Hq % Hkv == 0, (Hq, Hkv)
        return {
            "x": _w((lambda *s: torch.randn(*s, dtype=torch.bfloat16) * 0.05)(B, Sq, D)),
            "k_cache": _w((lambda *s: torch.randn(*s, dtype=torch.bfloat16) * 6.4)(B, Hkv, Sk, Dh)),
            "v_cache": _w((lambda *s: torch.randn(*s, dtype=torch.bfloat16) * 0.2)(B, Hkv, Sk, Dh)),
            "wq": _w((lambda *s: torch.randn(*s, dtype=torch.bfloat16) * 6.4)(D, Hq * Dh) * (D ** -0.5)),
            "wo": _w((lambda *s: torch.randn(*s, dtype=torch.bfloat16) * 0.2)(Hq * Dh, D) * ((Hq * Dh) ** -0.5)),
        }
    _A_in = _A_setup()

    def _B_setup():
        B, S, D, F = 2, 1, 512, 1792
        return {
            "x": _w((lambda *s: torch.randn(*s, dtype=torch.bfloat16) * 0.05)(B, S, D)),
            "w_gate": _w((lambda *s: torch.randn(*s, dtype=torch.bfloat16) * 0.05)(D, F)),
            "w_up": _w((lambda *s: torch.randn(*s, dtype=torch.bfloat16) * 0.05)(D, F)),
            "w_down": _w((lambda *s: torch.randn(*s, dtype=torch.bfloat16) * 0.05)(F, D)),
        }
    _B_in = _B_setup()

    return {
        "A_x": _A_in["x"],
        "A_k_cache": _A_in["k_cache"],
        "A_v_cache": _A_in["v_cache"],
        "A_wq": _A_in["wq"],
        "A_wo": _A_in["wo"],
        "B_x": _B_in["x"],
        "B_w_gate": _B_in["w_gate"],
        "B_w_up": _B_in["w_up"],
        "B_w_down": _B_in["w_down"],
        "gate_w": _w((lambda *s: torch.randn(*s, dtype=torch.bfloat16) * 0.05)(512) * 16.0),
    }

def reference(A_x, A_k_cache, A_v_cache, A_wq, A_wo, B_x, B_w_gate, B_w_up, B_w_down, gate_w):
    def _A_ref(x, k_cache, v_cache, wq, wo):
        B, Sq, D = x.shape
        Hq, Dh = 32, 128
        Hkv, Sk = k_cache.shape[1], k_cache.shape[2]
        W = min(4096, max(256, Sk // 4))
        rep = Hq // Hkv
        q = (lambda x, *d: x.permute(*d))((x @ wq).reshape(B, Sq, Hq, Dh), 0, 2, 1, 3)
        k = (lambda x, n, axis: torch.repeat_interleave(x, n, dim=axis))(k_cache[:, :, Sk - W:, :], rep, axis=1)
        v = (lambda x, n, axis: torch.repeat_interleave(x, n, dim=axis))(v_cache[:, :, Sk - W:, :], rep, axis=1)
        scores = torch.einsum("bhqd,bhkd->bhqk", q, k) * (Dh ** -0.5)
        p = _softmax(scores, axis=-1)
        o = torch.einsum("bhqk,bhkd->bhqd", p, v)
        return (lambda x, *d: x.permute(*d))(o, 0, 2, 1, 3).reshape(B, Sq, Hq * Dh) @ wo

    def _B_ref(x, w_gate, w_up, w_down):
        g = _silu(x @ w_gate)
        u = x @ w_up
        return (g * u) @ w_down

    x = A_x
    g = _sigmoid((x * gate_w).sum(-1, keepdims=True))
    a = _A_ref(x, A_k_cache, A_v_cache, A_wq, A_wo)
    b = _B_ref(x, B_w_gate, B_w_up, B_w_down)
    return g * a + (1 - g) * b
```

```asm
; @launch grid=(256,1,1) block=(1024,1,1) lds=22528
.amdgcn_target "amdgcn-amd-amdhsa--gfx950"
.text
.globl gated_mix__sliding_block_cached__swiglu_ffn__decode_kernel
.p2align 8
.type gated_mix__sliding_block_cached__swiglu_ffn__decode_kernel,@function
gated_mix__sliding_block_cached__swiglu_ffn__decode_kernel:
  s_cmp_ge_u32 s2, 256
  s_cbranch_scc1 L_end
  s_load_dwordx16 s[52:67], s[0:1], 0
  s_load_dwordx8 s[68:75], s[0:1], 64
  s_load_dwordx2 s[76:77], s[0:1], 96
  s_getreg_b32 s38, hwreg(HW_REG_XCC_ID)
  v_lshrrev_b32 v1, 6, v0
  v_and_b32 v0, 63, v0
  v_readfirstlane_b32 s3, v1
  v_and_b32 v1, 15, v0
  v_lshrrev_b32 v2, 4, v0
  v_mov_b32 v3, 0xffffff00
  v_lshlrev_b32 v4, 4, v0
  s_and_b32 s38, s38, 7
  s_add_u32 s38, s38, 1
  s_and_b32 s30, s2, 7
  s_lshr_b32 s31, s2, 5
  s_and_b32 s83, s2, 1
  s_sub_u32 s29, 4, s83
  s_lshr_b32 s28, s30, 1
  s_mul_i32 s28, s28, 7
  s_lshl_b32 s83, s83, 2
  s_add_u32 s39, s28, s83
  s_lshl_b32 s28, s39, 3
  s_mul_i32 s83, s31, s29
  s_add_u32 s28, s28, s83
  s_lshl_b32 s28, s28, 3
  s_mov_b32 s80, 0x05040100
  s_mov_b32 s81, 0x07060302
  s_cmp_ge_u32 s3, 12
  s_cbranch_scc1 L_cw
  s_cmp_ge_u32 s3, 4
  s_cbranch_scc1 L_attn
  s_cmp_eq_u32 s3, 3
  s_cbranch_scc1 L_h3
  v_and_b32 v5, 1, v1
  v_lshlrev_b32 v5, 10, v5
  v_bfe_u32 v6, v1, 1, 1
  v_lshl_add_u32 v5, v6, 6, v5
  v_lshl_add_u32 v5, v2, 4, v5
  v_lshrrev_b32 v6, 3, v1
  v_lshlrev_b32 v6, 2, v6
  v_add_u32 v6, v6, v2
  v_lshlrev_b32 v6, 3, v6
  v_and_b32 v7, 7, v1
  v_lshlrev_b32 v7, 4, v7
  s_mov_b32 s42, 0
  s_cmp_eq_u32 s3, 0
  s_cbranch_scc0 L_h12
  v_lshlrev_b32 v8, 13, v6
  v_add_u32 v8, v8, v7
  s_bfe_u32 s84, s2, 0x20003
  s_lshl_b32 s85, s30, 3
  s_add_u32 s85, s85, s31
  s_lshl_b32 s82, s84, 20
  s_lshl_b32 s83, s85, 7
  s_add_u32 s82, s82, s83
  s_lshl_b32 s83, s84, 8
  s_waitcnt lgkmcnt(0)
  s_mov_b32 s4, s52
  s_and_b32 s5, s53, 0xffff
  s_mov_b32 s6, 2048
  s_mov_b32 s7, 0x20000
  s_mov_b32 s8, s58
  s_and_b32 s9, s59, 0xffff
  s_mov_b32 s10, 4194304
  s_mov_b32 s11, 0x20000
  buffer_load_dwordx4 v[112:115], v5, s[4:7], s83 offen offset:0
  buffer_load_dwordx4 v[116:119], v5, s[4:7], s83 offen offset:128
  buffer_load_dwordx4 v[16:19], v8, s[8:11], s82 offen nt
  s_add_u32 s82, s82, 8192
  buffer_load_dwordx4 v[20:23], v8, s[8:11], s82 offen nt
  s_add_u32 s82, s82, 8192
  buffer_load_dwordx4 v[24:27], v8, s[8:11], s82 offen nt
  s_add_u32 s82, s82, 8192
  buffer_load_dwordx4 v[28:31], v8, s[8:11], s82 offen nt
  s_add_u32 s82, s82, 8192
  buffer_load_dwordx4 v[32:35], v8, s[8:11], s82 offen nt
  s_add_u32 s82, s82, 8192
  buffer_load_dwordx4 v[36:39], v8, s[8:11], s82 offen nt
  s_add_u32 s82, s82, 8192
  buffer_load_dwordx4 v[40:43], v8, s[8:11], s82 offen nt
  s_add_u32 s82, s82, 8192
  buffer_load_dwordx4 v[44:47], v8, s[8:11], s82 offen nt
  s_add_u32 s82, s82, 466944
  buffer_load_dwordx4 v[48:51], v8, s[8:11], s82 offen nt
  s_add_u32 s82, s82, 8192
  buffer_load_dwordx4 v[52:55], v8, s[8:11], s82 offen nt
  s_add_u32 s82, s82, 8192
  buffer_load_dwordx4 v[56:59], v8, s[8:11], s82 offen nt
  s_add_u32 s82, s82, 8192
  buffer_load_dwordx4 v[60:63], v8, s[8:11], s82 offen nt
  s_add_u32 s82, s82, 8192
  buffer_load_dwordx4 v[64:67], v8, s[8:11], s82 offen nt
  s_add_u32 s82, s82, 8192
  buffer_load_dwordx4 v[68:71], v8, s[8:11], s82 offen nt
  s_add_u32 s82, s82, 8192
  buffer_load_dwordx4 v[72:75], v8, s[8:11], s82 offen nt
  s_add_u32 s82, s82, 8192
  buffer_load_dwordx4 v[76:79], v8, s[8:11], s82 offen nt
  s_barrier
  s_load_dword s78, s[76:77], 0
  s_mov_b32 s16, s76
  s_and_b32 s17, s77, 0xffff
  s_mov_b32 s18, 536870912
  s_mov_b32 s19, 0x20000
  v_lshrrev_b32 v12, 1, v2
  v_lshlrev_b32 v12, 14, v12
  v_and_b32 v13, 1, v2
  v_lshl_add_u32 v12, v13, 4, v12
  v_lshl_add_u32 v104, v7, 1, v12
  s_lshl_b32 s41, s84, 15
  s_lshl_b32 s83, s85, 8
  s_add_u32 s41, s41, s83
  s_add_u32 s41, s41, 131072
  s_mov_b32 s40, 1
  s_waitcnt vmcnt(8)
  v_perm_b32 v80, v20, v16, s80
  v_perm_b32 v84, v20, v16, s81
  v_perm_b32 v88, v21, v17, s80
  v_perm_b32 v92, v21, v17, s81
  v_perm_b32 v96, v22, v18, s80
  v_perm_b32 v100, v22, v18, s81
  v_perm_b32 v104, v23, v19, s80
  v_perm_b32 v108, v23, v19, s81
  v_perm_b32 v81, v28, v24, s80
  v_perm_b32 v85, v28, v24, s81
  v_perm_b32 v89, v29, v25, s80
  v_perm_b32 v93, v29, v25, s81
  v_perm_b32 v97, v30, v26, s80
  v_perm_b32 v101, v30, v26, s81
  v_perm_b32 v105, v31, v27, s80
  v_perm_b32 v109, v31, v27, s81
  v_perm_b32 v82, v36, v32, s80
  v_perm_b32 v86, v36, v32, s81
  v_perm_b32 v90, v37, v33, s80
  v_perm_b32 v94, v37, v33, s81
  v_perm_b32 v98, v38, v34, s80
  v_perm_b32 v102, v38, v34, s81
  v_perm_b32 v106, v39, v35, s80
  v_perm_b32 v110, v39, v35, s81
  v_perm_b32 v83, v44, v40, s80
  v_perm_b32 v87, v44, v40, s81
  v_perm_b32 v91, v45, v41, s80
  v_perm_b32 v95, v45, v41, s81
  v_perm_b32 v99, v46, v42, s80
  v_perm_b32 v103, v46, v42, s81
  v_perm_b32 v107, v47, v43, s80
  v_perm_b32 v111, v47, v43, s81
  v_mfma_f32_16x16x32_bf16 v[16:19], v[112:115], v[80:83], 0
  v_mfma_f32_16x16x32_bf16 v[20:23], v[112:115], v[84:87], 0
  v_mfma_f32_16x16x32_bf16 v[24:27], v[112:115], v[88:91], 0
  v_mfma_f32_16x16x32_bf16 v[28:31], v[112:115], v[92:95], 0
  v_mfma_f32_16x16x32_bf16 v[32:35], v[112:115], v[96:99], 0
  v_mfma_f32_16x16x32_bf16 v[36:39], v[112:115], v[100:103], 0
  v_mfma_f32_16x16x32_bf16 v[40:43], v[112:115], v[104:107], 0
  v_mfma_f32_16x16x32_bf16 v[44:47], v[112:115], v[108:111], 0
  s_waitcnt vmcnt(0)
  v_perm_b32 v80, v52, v48, s80
  v_perm_b32 v84, v52, v48, s81
  v_perm_b32 v88, v53, v49, s80
  v_perm_b32 v92, v53, v49, s81
  v_perm_b32 v96, v54, v50, s80
  v_perm_b32 v100, v54, v50, s81
  v_perm_b32 v104, v55, v51, s80
  v_perm_b32 v108, v55, v51, s81
  v_perm_b32 v81, v60, v56, s80
  v_perm_b32 v85, v60, v56, s81
  v_perm_b32 v89, v61, v57, s80
  v_perm_b32 v93, v61, v57, s81
  v_perm_b32 v97, v62, v58, s80
  v_perm_b32 v101, v62, v58, s81
  v_perm_b32 v105, v63, v59, s80
  v_perm_b32 v109, v63, v59, s81
  v_perm_b32 v82, v68, v64, s80
  v_perm_b32 v86, v68, v64, s81
  v_perm_b32 v90, v69, v65, s80
  v_perm_b32 v94, v69, v65, s81
  v_perm_b32 v98, v70, v66, s80
  v_perm_b32 v102, v70, v66, s81
  v_perm_b32 v106, v71, v67, s80
  v_perm_b32 v110, v71, v67, s81
  v_perm_b32 v83, v76, v72, s80
  v_perm_b32 v87, v76, v72, s81
  v_perm_b32 v91, v77, v73, s80
  v_perm_b32 v95, v77, v73, s81
  v_perm_b32 v99, v78, v74, s80
  v_perm_b32 v103, v78, v74, s81
  v_perm_b32 v107, v79, v75, s80
  v_perm_b32 v111, v79, v75, s81
  v_mfma_f32_16x16x32_bf16 v[16:19], v[116:119], v[80:83], v[16:19]
  v_mfma_f32_16x16x32_bf16 v[20:23], v[116:119], v[84:87], v[20:23]
  v_mfma_f32_16x16x32_bf16 v[24:27], v[116:119], v[88:91], v[24:27]
  v_mfma_f32_16x16x32_bf16 v[28:31], v[116:119], v[92:95], v[28:31]
  v_mfma_f32_16x16x32_bf16 v[32:35], v[116:119], v[96:99], v[32:35]
  v_mfma_f32_16x16x32_bf16 v[36:39], v[116:119], v[100:103], v[36:39]
  v_mfma_f32_16x16x32_bf16 v[40:43], v[116:119], v[104:107], v[40:43]
  v_mfma_f32_16x16x32_bf16 v[44:47], v[116:119], v[108:111], v[44:47]
  s_waitcnt lgkmcnt(0)
  s_add_u32 s79, s78, 1
  s_mul_i32 s79, s79, 9
  s_mul_i32 s37, s79, 0x9E3779B1
  s_add_u32 s79, s79, s38
  s_mul_i32 s36, s79, 0x9E3779B1
  s_and_b32 s20, s36, 0xff
  s_bfe_u32 s21, s36, 0x80008
  s_bfe_u32 s22, s36, 0x80010
  s_lshr_b32 s23, s36, 24
  s_and_b32 s24, s37, 0xff
  s_bfe_u32 s25, s37, 0x80008
  s_bfe_u32 s26, s37, 0x80010
  s_lshr_b32 s27, s37, 24
  s_mov_b32 exec_lo, 0xffff
  s_mov_b32 exec_hi, 0x0
  v_add_f32_dpp v100, v18, v16 row_ror:8 row_mask:0xf bank_mask:0xf
  v_add_f32_dpp v101, v22, v20 row_ror:8 row_mask:0xf bank_mask:0xf
  v_add_f32_dpp v102, v26, v24 row_ror:8 row_mask:0xf bank_mask:0xf
  v_add_f32_dpp v103, v30, v28 row_ror:8 row_mask:0xf bank_mask:0xf
  s_mov_b32 exec_lo, 0xffff0000
  s_mov_b32 exec_hi, 0x0
  v_add_f32_dpp v100, v34, v32 row_ror:8 row_mask:0xf bank_mask:0xf
  v_add_f32_dpp v101, v38, v36 row_ror:8 row_mask:0xf bank_mask:0xf
  v_add_f32_dpp v102, v42, v40 row_ror:8 row_mask:0xf bank_mask:0xf
  v_add_f32_dpp v103, v46, v44 row_ror:8 row_mask:0xf bank_mask:0xf
  s_mov_b32 exec_lo, 0x0
  s_mov_b32 exec_hi, 0xffff
  v_add_f32_dpp v100, v19, v17 row_ror:8 row_mask:0xf bank_mask:0xf
  v_add_f32_dpp v101, v23, v21 row_ror:8 row_mask:0xf bank_mask:0xf
  v_add_f32_dpp v102, v27, v25 row_ror:8 row_mask:0xf bank_mask:0xf
  v_add_f32_dpp v103, v31, v29 row_ror:8 row_mask:0xf bank_mask:0xf
  s_mov_b32 exec_lo, 0x0
  s_mov_b32 exec_hi, 0xffff0000
  v_add_f32_dpp v100, v35, v33 row_ror:8 row_mask:0xf bank_mask:0xf
  v_add_f32_dpp v101, v39, v37 row_ror:8 row_mask:0xf bank_mask:0xf
  v_add_f32_dpp v102, v43, v41 row_ror:8 row_mask:0xf bank_mask:0xf
  v_add_f32_dpp v103, v47, v45 row_ror:8 row_mask:0xf bank_mask:0xf
  s_mov_b64 exec, -1
  v_lshl_add_u32 v104, v7, 1, v12
  v_and_or_b32 v100, v100, v3, s20
  v_and_or_b32 v101, v101, v3, s21
  v_and_or_b32 v102, v102, v3, s22
  v_and_or_b32 v103, v103, v3, s23
  s_mov_b32 exec_lo, 0xff00ff
  s_mov_b32 exec_hi, 0xff00ff
  buffer_store_dwordx4 v[100:103], v104, s[16:19], s41 offen
  s_mov_b64 exec, -1
  v_mov_b32 v8, 0
  v_mov_b32 v9, 1
  s_mov_b64 s[46:47], exec
  s_mov_b32 exec_lo, 0x1
  s_mov_b32 exec_hi, 0x0
  ds_add_u32 v8, v9 offset:1280
  s_mov_b64 exec, s[46:47]
  s_branch L_hrel
L_h12:
  s_movk_i32 s82, 3584
  v_mul_lo_u32 v8, v6, s82
  v_add_u32 v8, v8, v7
  s_bfe_u32 s84, s2, 0x30003
  s_lshr_b32 s43, s2, 6
  s_add_u32 s85, s39, s43
  s_mul_i32 s82, s84, 229376
  s_lshl_b32 s83, s85, 7
  s_add_u32 s82, s82, s83
  s_lshl_b32 s83, s84, 7
  s_mov_b32 s40, 0
  s_waitcnt lgkmcnt(0)
  s_mov_b32 s4, s52
  s_and_b32 s5, s53, 0xffff
  s_mov_b32 s6, 2048
  s_mov_b32 s7, 0x20000
  s_cmp_eq_u32 s3, 1
  s_cselect_b32 s8, s64, s66
  s_cselect_b32 s9, s65, s67
  s_and_b32 s9, s9, 0xffff
  s_mov_b32 s10, 1835008
  s_mov_b32 s11, 0x20000
  s_cmp_eq_u32 s3, 1
  s_cbranch_scc1 L_h12a
  s_mov_b32 s12, s70
  s_and_b32 s13, s71, 0xffff
  s_mov_b32 s14, 1024
  s_mov_b32 s15, 0x20000
  buffer_load_dwordx4 v[116:119], v4, s[4:7], 0 offen
  buffer_load_dwordx4 v[120:123], v4, s[4:7], 0 offen offset:1024
  buffer_load_dwordx4 v[124:127], v4, s[12:15], 0 offen
L_h12a:
  s_cmp_ge_u32 s43, s29
  s_cbranch_scc1 L_h12_skip
  buffer_load_dwordx4 v[112:115], v5, s[4:7], s83 offen offset:0
  buffer_load_dwordx4 v[16:19], v8, s[8:11], s82 offen nt
  s_add_u32 s82, s82, 3584
  buffer_load_dwordx4 v[20:23], v8, s[8:11], s82 offen nt
  s_add_u32 s82, s82, 3584
  buffer_load_dwordx4 v[24:27], v8, s[8:11], s82 offen nt
  s_add_u32 s82, s82, 3584
  buffer_load_dwordx4 v[28:31], v8, s[8:11], s82 offen nt
  s_add_u32 s82, s82, 3584
  buffer_load_dwordx4 v[32:35], v8, s[8:11], s82 offen nt
  s_add_u32 s82, s82, 3584
  buffer_load_dwordx4 v[36:39], v8, s[8:11], s82 offen nt
  s_add_u32 s82, s82, 3584
  buffer_load_dwordx4 v[40:43], v8, s[8:11], s82 offen nt
  s_add_u32 s82, s82, 3584
  buffer_load_dwordx4 v[44:47], v8, s[8:11], s82 offen nt
L_h12_skip:
  s_barrier
  s_load_dword s78, s[76:77], 0
  s_mov_b32 s16, s76
  s_and_b32 s17, s77, 0xffff
  s_mov_b32 s18, 536870912
  s_mov_b32 s19, 0x20000
  s_cmp_ge_u32 s43, s29
  s_cbranch_scc1 L_h12_none
  v_lshrrev_b32 v12, 1, v2
  v_mul_u32_u24 v12, 7168, v12
  v_and_b32 v13, 1, v2
  v_lshl_add_u32 v12, v13, 4, v12
  s_mul_i32 s41, s84, 14336
  s_lshl_b32 s83, s85, 8
  s_add_u32 s41, s41, s83
  s_sub_u32 s83, s3, 1
  s_lshl_b32 s83, s83, 17
  s_add_u32 s41, s41, s83
  s_add_u32 s41, s41, 262144
  s_mov_b32 s40, 1
  s_waitcnt vmcnt(0)
  v_perm_b32 v80, v20, v16, s80
  v_perm_b32 v84, v20, v16, s81
  v_perm_b32 v88, v21, v17, s80
  v_perm_b32 v92, v21, v17, s81
  v_perm_b32 v96, v22, v18, s80
  v_perm_b32 v100, v22, v18, s81
  v_perm_b32 v104, v23, v19, s80
  v_perm_b32 v108, v23, v19, s81
  v_perm_b32 v81, v28, v24, s80
  v_perm_b32 v85, v28, v24, s81
  v_perm_b32 v89, v29, v25, s80
  v_perm_b32 v93, v29, v25, s81
  v_perm_b32 v97, v30, v26, s80
  v_perm_b32 v101, v30, v26, s81
  v_perm_b32 v105, v31, v27, s80
  v_perm_b32 v109, v31, v27, s81
  v_perm_b32 v82, v36, v32, s80
  v_perm_b32 v86, v36, v32, s81
  v_perm_b32 v90, v37, v33, s80
  v_perm_b32 v94, v37, v33, s81
  v_perm_b32 v98, v38, v34, s80
  v_perm_b32 v102, v38, v34, s81
  v_perm_b32 v106, v39, v35, s80
  v_perm_b32 v110, v39, v35, s81
  v_perm_b32 v83, v44, v40, s80
  v_perm_b32 v87, v44, v40, s81
  v_perm_b32 v91, v45, v41, s80
  v_perm_b32 v95, v45, v41, s81
  v_perm_b32 v99, v46, v42, s80
  v_perm_b32 v103, v46, v42, s81
  v_perm_b32 v107, v47, v43, s80
  v_perm_b32 v111, v47, v43, s81
  v_mfma_f32_16x16x32_bf16 v[16:19], v[112:115], v[80:83], 0
  v_mfma_f32_16x16x32_bf16 v[20:23], v[112:115], v[84:87], 0
  v_mfma_f32_16x16x32_bf16 v[24:27], v[112:115], v[88:91], 0
  v_mfma_f32_16x16x32_bf16 v[28:31], v[112:115], v[92:95], 0
  v_mfma_f32_16x16x32_bf16 v[32:35], v[112:115], v[96:99], 0
  v_mfma_f32_16x16x32_bf16 v[36:39], v[112:115], v[100:103], 0
  v_mfma_f32_16x16x32_bf16 v[40:43], v[112:115], v[104:107], 0
  v_mfma_f32_16x16x32_bf16 v[44:47], v[112:115], v[108:111], 0
  s_waitcnt lgkmcnt(0)
  s_add_u32 s79, s78, 1
  s_mul_i32 s79, s79, 9
  s_mul_i32 s37, s79, 0x9E3779B1
  s_add_u32 s79, s79, s38
  s_mul_i32 s36, s79, 0x9E3779B1
  s_and_b32 s20, s36, 0xff
  s_bfe_u32 s21, s36, 0x80008
  s_bfe_u32 s22, s36, 0x80010
  s_lshr_b32 s23, s36, 24
  s_and_b32 s24, s37, 0xff
  s_bfe_u32 s25, s37, 0x80008
  s_bfe_u32 s26, s37, 0x80010
  s_lshr_b32 s27, s37, 24
  s_mov_b32 exec_lo, 0xffff
  s_mov_b32 exec_hi, 0x0
  v_add_f32_dpp v100, v18, v16 row_ror:8 row_mask:0xf bank_mask:0xf
  v_add_f32_dpp v101, v22, v20 row_ror:8 row_mask:0xf bank_mask:0xf
  v_add_f32_dpp v102, v26, v24 row_ror:8 row_mask:0xf bank_mask:0xf
  v_add_f32_dpp v103, v30, v28 row_ror:8 row_mask:0xf bank_mask:0xf
  s_mov_b32 exec_lo, 0xffff0000
  s_mov_b32 exec_hi, 0x0
  v_add_f32_dpp v100, v34, v32 row_ror:8 row_mask:0xf bank_mask:0xf
  v_add_f32_dpp v101, v38, v36 row_ror:8 row_mask:0xf bank_mask:0xf
  v_add_f32_dpp v102, v42, v40 row_ror:8 row_mask:0xf bank_mask:0xf
  v_add_f32_dpp v103, v46, v44 row_ror:8 row_mask:0xf bank_mask:0xf
  s_mov_b32 exec_lo, 0x0
  s_mov_b32 exec_hi, 0xffff
  v_add_f32_dpp v100, v19, v17 row_ror:8 row_mask:0xf bank_mask:0xf
  v_add_f32_dpp v101, v23, v21 row_ror:8 row_mask:0xf bank_mask:0xf
  v_add_f32_dpp v102, v27, v25 row_ror:8 row_mask:0xf bank_mask:0xf
  v_add_f32_dpp v103, v31, v29 row_ror:8 row_mask:0xf bank_mask:0xf
  s_mov_b32 exec_lo, 0x0
  s_mov_b32 exec_hi, 0xffff0000
  v_add_f32_dpp v100, v35, v33 row_ror:8 row_mask:0xf bank_mask:0xf
  v_add_f32_dpp v101, v39, v37 row_ror:8 row_mask:0xf bank_mask:0xf
  v_add_f32_dpp v102, v43, v41 row_ror:8 row_mask:0xf bank_mask:0xf
  v_add_f32_dpp v103, v47, v45 row_ror:8 row_mask:0xf bank_mask:0xf
  s_mov_b64 exec, -1
  v_lshl_add_u32 v104, v7, 1, v12
  v_and_or_b32 v100, v100, v3, s20
  v_and_or_b32 v101, v101, v3, s21
  v_and_or_b32 v102, v102, v3, s22
  v_and_or_b32 v103, v103, v3, s23
  s_mov_b32 exec_lo, 0xff00ff
  s_mov_b32 exec_hi, 0xff00ff
  buffer_store_dwordx4 v[100:103], v104, s[16:19], s41 offen
  s_mov_b64 exec, -1
  s_nop 0
  s_branch L_h12_done
L_h12_none:
  v_mov_b32 v104, 0
  s_mov_b32 s41, 268435456
  s_waitcnt lgkmcnt(0)
  s_add_u32 s79, s78, 1
  s_mul_i32 s79, s79, 9
  s_mul_i32 s37, s79, 0x9E3779B1
  s_add_u32 s79, s79, s38
  s_mul_i32 s36, s79, 0x9E3779B1
  s_and_b32 s20, s36, 0xff
  s_bfe_u32 s21, s36, 0x80008
  s_bfe_u32 s22, s36, 0x80010
  s_lshr_b32 s23, s36, 24
  s_and_b32 s24, s37, 0xff
  s_bfe_u32 s25, s37, 0x80008
  s_bfe_u32 s26, s37, 0x80010
  s_lshr_b32 s27, s37, 24
L_h12_done:
  s_cmp_eq_u32 s3, 2
  s_cbranch_scc1 L_ffn
  v_mov_b32 v8, 0
  v_mov_b32 v9, 1
  s_mov_b64 s[46:47], exec
  s_mov_b32 exec_lo, 0x1
  s_mov_b32 exec_hi, 0x0
  ds_add_u32 v8, v9 offset:1280
  s_mov_b64 exec, s[46:47]
  s_branch L_hrel
L_qgather:
  s_and_b32 s82, s2, 15
  s_lshl_b32 s82, s82, 11
  s_add_u32 s82, s82, 131072
  s_add_u32 s83, s82, 32768
  s_add_u32 s84, s82, 65536
  s_add_u32 s85, s82, 98304
  v_mov_b32 v8, 0
  s_mov_b32 s79, 0
  v_mov_b32 v11, 0
  s_nop 1
L_lw_1:
  ds_read_b32 v10, v11 offset:1300
  s_waitcnt lgkmcnt(0)
  v_cmp_gt_u32 vcc, 3, v10
  s_nop 0
  s_cbranch_vccz L_lok_2
  s_sleep 1
  s_add_u32 s79, s79, 1
  s_cmp_lt_u32 s79, 960000
  s_cbranch_scc1 L_lw_1
L_lok_2:
  s_mov_b32 exec_lo, 0x1
  s_mov_b32 exec_hi, 0x0
  buffer_load_dword v9, v8, s[16:19], 0 offen offset:256
  s_mov_b64 exec, -1
  s_waitcnt vmcnt(0)
  buffer_load_dwordx4 v[16:19], v4, s[16:19], s82 offen offset:0 sc1
  buffer_load_dwordx4 v[20:23], v4, s[16:19], s82 offen offset:1024 sc1
  buffer_load_dwordx4 v[24:27], v4, s[16:19], s83 offen offset:0 sc1
  buffer_load_dwordx4 v[28:31], v4, s[16:19], s83 offen offset:1024 sc1
  buffer_load_dwordx4 v[32:35], v4, s[16:19], s84 offen offset:0 sc1
  buffer_load_dwordx4 v[36:39], v4, s[16:19], s84 offen offset:1024 sc1
  buffer_load_dwordx4 v[40:43], v4, s[16:19], s85 offen offset:0 sc1
  buffer_load_dwordx4 v[44:47], v4, s[16:19], s85 offen offset:1024 sc1
  v_mov_b32 v8, 0
  v_mov_b32 v9, 1
  s_mov_b64 s[46:47], exec
  s_mov_b32 exec_lo, 0x1
  s_mov_b32 exec_hi, 0x0
  ds_add_u32 v8, v9 offset:1312
  s_mov_b64 exec, s[46:47]
  s_mov_b32 s79, 0
  s_branch L_pwt_5
L_poll_3:
  buffer_load_dwordx4 v[16:19], v4, s[16:19], s82 offen offset:0 sc1
  buffer_load_dwordx4 v[20:23], v4, s[16:19], s82 offen offset:1024 sc1
  buffer_load_dwordx4 v[24:27], v4, s[16:19], s83 offen offset:0 sc1
  buffer_load_dwordx4 v[28:31], v4, s[16:19], s83 offen offset:1024 sc1
  buffer_load_dwordx4 v[32:35], v4, s[16:19], s84 offen offset:0 sc1
  buffer_load_dwordx4 v[36:39], v4, s[16:19], s84 offen offset:1024 sc1
  buffer_load_dwordx4 v[40:43], v4, s[16:19], s85 offen offset:0 sc1
  buffer_load_dwordx4 v[44:47], v4, s[16:19], s85 offen offset:1024 sc1
L_pwt_5:
  s_waitcnt vmcnt(0)
  v_xor_b32 v16, s20, v16
  v_xor_b32 v17, s21, v17
  v_or_b32 v8, v16, v17
  v_xor_b32 v18, s22, v18
  v_xor_b32 v19, s23, v19
  v_or3_b32 v8, v8, v18, v19
  v_xor_b32 v20, s20, v20
  v_xor_b32 v21, s21, v21
  v_or3_b32 v8, v8, v20, v21
  v_xor_b32 v22, s22, v22
  v_xor_b32 v23, s23, v23
  v_or3_b32 v8, v8, v22, v23
  v_xor_b32 v24, s20, v24
  v_xor_b32 v25, s21, v25
  v_or3_b32 v8, v8, v24, v25
  v_xor_b32 v26, s22, v26
  v_xor_b32 v27, s23, v27
  v_or3_b32 v8, v8, v26, v27
  v_xor_b32 v28, s20, v28
  v_xor_b32 v29, s21, v29
  v_or3_b32 v8, v8, v28, v29
  v_xor_b32 v30, s22, v30
  v_xor_b32 v31, s23, v31
  v_or3_b32 v8, v8, v30, v31
  v_xor_b32 v32, s20, v32
  v_xor_b32 v33, s21, v33
  v_or3_b32 v8, v8, v32, v33
  v_xor_b32 v34, s22, v34
  v_xor_b32 v35, s23, v35
  v_or3_b32 v8, v8, v34, v35
  v_xor_b32 v36, s20, v36
  v_xor_b32 v37, s21, v37
  v_or3_b32 v8, v8, v36, v37
  v_xor_b32 v38, s22, v38
  v_xor_b32 v39, s23, v39
  v_or3_b32 v8, v8, v38, v39
  v_xor_b32 v40, s20, v40
  v_xor_b32 v41, s21, v41
  v_or3_b32 v8, v8, v40, v41
  v_xor_b32 v42, s22, v42
  v_xor_b32 v43, s23, v43
  v_or3_b32 v8, v8, v42, v43
  v_xor_b32 v44, s20, v44
  v_xor_b32 v45, s21, v45
  v_or3_b32 v8, v8, v44, v45
  v_xor_b32 v46, s22, v46
  v_xor_b32 v47, s23, v47
  v_or3_b32 v8, v8, v46, v47
  v_and_b32 v8, 0xff, v8
  v_cmp_ne_u32 vcc, 0, v8
  s_nop 0
  s_cbranch_vccz L_pok_4
  s_mov_b64 exec, vcc
  s_add_u32 s79, s79, 1
  s_cmp_lt_u32 s79, 150
  s_cbranch_scc1 L_poll_3
  s_branch L_slow_6
L_pok_4:
  s_mov_b64 exec, -1
  v_add_f32 v16, v16, v24
  v_add_f32 v32, v32, v40
  v_add_f32 v17, v17, v25
  v_add_f32 v33, v33, v41
  v_add_f32 v18, v18, v26
  v_add_f32 v34, v34, v42
  v_add_f32 v19, v19, v27
  v_add_f32 v35, v35, v43
  v_add_f32 v20, v20, v28
  v_add_f32 v36, v36, v44
  v_add_f32 v21, v21, v29
  v_add_f32 v37, v37, v45
  v_add_f32 v22, v22, v30
  v_add_f32 v38, v38, v46
  v_add_f32 v23, v23, v31
  v_add_f32 v39, v39, v47
  v_add_f32 v16, v16, v32
  v_add_f32 v17, v17, v33
  v_add_f32 v18, v18, v34
  v_add_f32 v19, v19, v35
  v_add_f32 v20, v20, v36
  v_add_f32 v21, v21, v37
  v_add_f32 v22, v22, v38
  v_add_f32 v23, v23, v39
  v_cvt_pk_bf16_f32 v8, v16, v17
  v_cvt_pk_bf16_f32 v9, v18, v19
  v_cvt_pk_bf16_f32 v10, v20, v21
  v_cvt_pk_bf16_f32 v11, v22, v23
  v_lshlrev_b32 v12, 3, v0
  ds_write_b64 v12, v[8:9] offset:0
  ds_write_b64 v12, v[10:11] offset:512
  s_waitcnt lgkmcnt(0)
  v_mov_b32 v8, 0
  v_mov_b32 v9, 1
  s_mov_b64 s[46:47], exec
  s_mov_b32 exec_lo, 0x1
  s_mov_b32 exec_hi, 0x0
  ds_add_u32 v8, v9 offset:1280
  s_mov_b64 exec, s[46:47]
  s_branch L_h3b
L_hrel:
  s_cmp_eq_u32 s42, 1
  s_cbranch_scc1 L_fin
  s_mov_b32 s79, 0
  v_mov_b32 v9, 0
  s_nop 1
L_rw_7:
  s_sleep 8
  ds_read_b32 v8, v9 offset:1308
  s_waitcnt lgkmcnt(0)
  v_readfirstlane_b32 s43, v8
  s_cmp_eq_u32 s43, 1
  s_nop 3
  s_cbranch_scc1 L_fin
  s_cmp_eq_u32 s43, 2
  s_cbranch_scc1 L_rs_8
  s_add_u32 s79, s79, 1
  s_cmp_lt_u32 s79, 120
  s_cbranch_scc1 L_rw_7
  v_mov_b32 v8, 0
  v_mov_b32 v9, 2
  s_mov_b64 s[46:47], exec
  s_mov_b32 exec_lo, 0x1
  s_mov_b32 exec_hi, 0x0
  ds_max_u32 v8, v9 offset:1308
  s_mov_b64 exec, s[46:47]
L_rs_8:
  s_cmp_eq_u32 s40, 0
  s_cbranch_scc1 L_nr_9
  v_and_or_b32 v100, v100, v3, s24
  v_and_or_b32 v101, v101, v3, s25
  v_and_or_b32 v102, v102, v3, s26
  v_and_or_b32 v103, v103, v3, s27
  s_mov_b32 exec_lo, 0xff00ff
  s_mov_b32 exec_hi, 0xff00ff
  buffer_store_dwordx4 v[100:103], v104, s[16:19], s41 offen sc1
  s_mov_b64 exec, -1
  s_nop 0
L_nr_9:
  s_branch L_fin
L_ffn:
  v_mov_b32 v8, 0
  v_mov_b32 v9, 1
  s_mov_b64 s[46:47], exec
  s_mov_b32 exec_lo, 0x1
  s_mov_b32 exec_hi, 0x0
  ds_add_u32 v8, v9 offset:1280
  s_mov_b64 exec, s[46:47]
  v_and_b32 v8, 7, v0
  v_mul_u32_u24 v8, 14336, v8
  v_lshrrev_b32 v9, 3, v0
  v_lshl_add_u32 v8, v9, 4, v8
  s_lshl_b32 s82, s28, 2
  s_add_u32 s82, s82, 262144
  s_add_u32 s83, s82, 7168
  s_add_u32 s84, s82, 131072
  s_add_u32 s85, s84, 7168
  s_waitcnt vmcnt(0)
  v_mov_b32 v14, 0
  v_mov_b32 v15, 0
  v_dot2_f32_bf16 v14, v116, v124, v14
  v_dot2_f32_bf16 v15, v120, v124, v15
  v_dot2_f32_bf16 v14, v117, v125, v14
  v_dot2_f32_bf16 v15, v121, v125, v15
  v_dot2_f32_bf16 v14, v118, v126, v14
  v_dot2_f32_bf16 v15, v122, v126, v15
  v_dot2_f32_bf16 v14, v119, v127, v14
  v_dot2_f32_bf16 v15, v123, v127, v15
  s_nop 3
  v_add_f32_dpp v14, v14, v14 row_ror:8 row_mask:0xf bank_mask:0xf
  v_add_f32_dpp v15, v15, v15 row_ror:8 row_mask:0xf bank_mask:0xf
  s_nop 0
  v_add_f32_dpp v14, v14, v14 row_ror:4 row_mask:0xf bank_mask:0xf
  v_add_f32_dpp v15, v15, v15 row_ror:4 row_mask:0xf bank_mask:0xf
  s_nop 0
  v_add_f32_dpp v14, v14, v14 row_ror:2 row_mask:0xf bank_mask:0xf
  v_add_f32_dpp v15, v15, v15 row_ror:2 row_mask:0xf bank_mask:0xf
  s_nop 0
  v_add_f32_dpp v14, v14, v14 row_ror:1 row_mask:0xf bank_mask:0xf
  v_add_f32_dpp v15, v15, v15 row_ror:1 row_mask:0xf bank_mask:0xf
  v_mov_b32 v10, v14
  v_mov_b32 v11, v15
  s_nop 0
  v_permlane16_swap_b32 v14, v10
  v_permlane16_swap_b32 v15, v11
  v_add_f32 v14, v14, v10
  v_add_f32 v15, v15, v11
  v_mov_b32 v10, v14
  v_mov_b32 v11, v15
  s_nop 0
  v_permlane32_swap_b32 v14, v10
  v_permlane32_swap_b32 v15, v11
  v_add_f32 v14, v14, v10
  v_add_f32 v15, v15, v11
  v_mul_f32 v14, 0xbfb8aa3b, v14
  v_mul_f32 v15, 0xbfb8aa3b, v15
  v_exp_f32 v14, v14
  v_exp_f32 v15, v15
  v_add_f32 v14, 1.0, v14
  v_add_f32 v15, 1.0, v15
  v_rcp_f32 v14, v14
  v_rcp_f32 v15, v15
  v_mov_b32 v16, 0
  v_mov_b32 v17, 0
  v_mov_b32 v18, 0
  v_mov_b32 v19, 0
  v_mov_b32 v20, 0
  v_mov_b32 v21, 0
  v_mov_b32 v22, 0
  v_mov_b32 v23, 0
  v_mov_b32 v24, 0
  v_mov_b32 v25, 0
  v_mov_b32 v26, 0
  v_mov_b32 v27, 0
  v_mov_b32 v28, 0
  v_mov_b32 v29, 0
  v_mov_b32 v30, 0
  v_mov_b32 v31, 0
  s_mov_b32 s79, 0
  v_mov_b32 v11, 0
  s_nop 1
L_lw_10:
  ds_read_b32 v10, v11 offset:1312
  s_waitcnt lgkmcnt(0)
  v_cmp_gt_u32 vcc, 1, v10
  s_nop 0
  s_cbranch_vccz L_lok_11
  s_sleep 2
  s_add_u32 s79, s79, 1
  s_cmp_lt_u32 s79, 960000
  s_cbranch_scc1 L_lw_10
L_lok_11:
  s_cmp_eq_u32 s29, 4
  s_cselect_b32 exec_hi, -1, 0xffff
  s_mov_b32 s79, 0
L_poll_12:
  buffer_load_dwordx4 v[16:19], v8, s[16:19], s82 offen sc1
  buffer_load_dwordx4 v[20:23], v8, s[16:19], s83 offen sc1
  buffer_load_dwordx4 v[24:27], v8, s[16:19], s84 offen sc1
  buffer_load_dwordx4 v[28:31], v8, s[16:19], s85 offen sc1
  s_waitcnt vmcnt(0)
  v_xor_b32 v16, s20, v16
  v_xor_b32 v17, s21, v17
  v_or_b32 v9, v16, v17
  v_xor_b32 v18, s22, v18
  v_xor_b32 v19, s23, v19
  v_or3_b32 v9, v9, v18, v19
  v_xor_b32 v20, s20, v20
  v_xor_b32 v21, s21, v21
  v_or3_b32 v9, v9, v20, v21
  v_xor_b32 v22, s22, v22
  v_xor_b32 v23, s23, v23
  v_or3_b32 v9, v9, v22, v23
  v_xor_b32 v24, s20, v24
  v_xor_b32 v25, s21, v25
  v_or3_b32 v9, v9, v24, v25
  v_xor_b32 v26, s22, v26
  v_xor_b32 v27, s23, v27
  v_or3_b32 v9, v9, v26, v27
  v_xor_b32 v28, s20, v28
  v_xor_b32 v29, s21, v29
  v_or3_b32 v9, v9, v28, v29
  v_xor_b32 v30, s22, v30
  v_xor_b32 v31, s23, v31
  v_or3_b32 v9, v9, v30, v31
  v_and_b32 v9, 0xff, v9
  v_cmp_ne_u32 vcc, 0, v9
  s_nop 0
  s_cbranch_vccz L_pok_13
  s_mov_b64 exec, vcc
  s_add_u32 s79, s79, 1
  s_cmp_lt_u32 s79, 150
  s_cbranch_scc1 L_poll_12
  s_branch L_slow_15
L_pok_13:
  s_mov_b64 exec, -1
  v_add_f32_dpp v16, v16, v16 quad_perm:[1,0,3,2] row_mask:0xf bank_mask:0xf
  v_add_f32_dpp v17, v17, v17 quad_perm:[1,0,3,2] row_mask:0xf bank_mask:0xf
  v_add_f32_dpp v18, v18, v18 quad_perm:[1,0,3,2] row_mask:0xf bank_mask:0xf
  v_add_f32_dpp v19, v19, v19 quad_perm:[1,0,3,2] row_mask:0xf bank_mask:0xf
  v_add_f32_dpp v20, v20, v20 quad_perm:[1,0,3,2] row_mask:0xf bank_mask:0xf
  v_add_f32_dpp v21, v21, v21 quad_perm:[1,0,3,2] row_mask:0xf bank_mask:0xf
  v_add_f32_dpp v22, v22, v22 quad_perm:[1,0,3,2] row_mask:0xf bank_mask:0xf
  v_add_f32_dpp v23, v23, v23 quad_perm:[1,0,3,2] row_mask:0xf bank_mask:0xf
  v_add_f32_dpp v24, v24, v24 quad_perm:[1,0,3,2] row_mask:0xf bank_mask:0xf
  v_add_f32_dpp v25, v25, v25 quad_perm:[1,0,3,2] row_mask:0xf bank_mask:0xf
  v_add_f32_dpp v26, v26, v26 quad_perm:[1,0,3,2] row_mask:0xf bank_mask:0xf
  v_add_f32_dpp v27, v27, v27 quad_perm:[1,0,3,2] row_mask:0xf bank_mask:0xf
  v_add_f32_dpp v28, v28, v28 quad_perm:[1,0,3,2] row_mask:0xf bank_mask:0xf
  v_add_f32_dpp v29, v29, v29 quad_perm:[1,0,3,2] row_mask:0xf bank_mask:0xf
  v_add_f32_dpp v30, v30, v30 quad_perm:[1,0,3,2] row_mask:0xf bank_mask:0xf
  v_add_f32_dpp v31, v31, v31 quad_perm:[1,0,3,2] row_mask:0xf bank_mask:0xf
  v_add_f32_dpp v16, v16, v16 quad_perm:[2,3,0,1] row_mask:0xf bank_mask:0xf
  v_add_f32_dpp v17, v17, v17 quad_perm:[2,3,0,1] row_mask:0xf bank_mask:0xf
  v_add_f32_dpp v18, v18, v18 quad_perm:[2,3,0,1] row_mask:0xf bank_mask:0xf
  v_add_f32_dpp v19, v19, v19 quad_perm:[2,3,0,1] row_mask:0xf bank_mask:0xf
  v_add_f32_dpp v20, v20, v20 quad_perm:[2,3,0,1] row_mask:0xf bank_mask:0xf
  v_add_f32_dpp v21, v21, v21 quad_perm:[2,3,0,1] row_mask:0xf bank_mask:0xf
  v_add_f32_dpp v22, v22, v22 quad_perm:[2,3,0,1] row_mask:0xf bank_mask:0xf
  v_add_f32_dpp v23, v23, v23 quad_perm:[2,3,0,1] row_mask:0xf bank_mask:0xf
  v_add_f32_dpp v24, v24, v24 quad_perm:[2,3,0,1] row_mask:0xf bank_mask:0xf
  v_add_f32_dpp v25, v25, v25 quad_perm:[2,3,0,1] row_mask:0xf bank_mask:0xf
  v_add_f32_dpp v26, v26, v26 quad_perm:[2,3,0,1] row_mask:0xf bank_mask:0xf
  v_add_f32_dpp v27, v27, v27 quad_perm:[2,3,0,1] row_mask:0xf bank_mask:0xf
  v_add_f32_dpp v28, v28, v28 quad_perm:[2,3,0,1] row_mask:0xf bank_mask:0xf
  v_add_f32_dpp v29, v29, v29 quad_perm:[2,3,0,1] row_mask:0xf bank_mask:0xf
  v_add_f32_dpp v30, v30, v30 quad_perm:[2,3,0,1] row_mask:0xf bank_mask:0xf
  v_add_f32_dpp v31, v31, v31 quad_perm:[2,3,0,1] row_mask:0xf bank_mask:0xf
  v_add_f32_dpp v16, v16, v16 row_half_mirror row_mask:0xf bank_mask:0xf
  v_add_f32_dpp v17, v17, v17 row_half_mirror row_mask:0xf bank_mask:0xf
  v_add_f32_dpp v18, v18, v18 row_half_mirror row_mask:0xf bank_mask:0xf
  v_add_f32_dpp v19, v19, v19 row_half_mirror row_mask:0xf bank_mask:0xf
  v_add_f32_dpp v20, v20, v20 row_half_mirror row_mask:0xf bank_mask:0xf
  v_add_f32_dpp v21, v21, v21 row_half_mirror row_mask:0xf bank_mask:0xf
  v_add_f32_dpp v22, v22, v22 row_half_mirror row_mask:0xf bank_mask:0xf
  v_add_f32_dpp v23, v23, v23 row_half_mirror row_mask:0xf bank_mask:0xf
  v_add_f32_dpp v24, v24, v24 row_half_mirror row_mask:0xf bank_mask:0xf
  v_add_f32_dpp v25, v25, v25 row_half_mirror row_mask:0xf bank_mask:0xf
  v_add_f32_dpp v26, v26, v26 row_half_mirror row_mask:0xf bank_mask:0xf
  v_add_f32_dpp v27, v27, v27 row_half_mirror row_mask:0xf bank_mask:0xf
  v_add_f32_dpp v28, v28, v28 row_half_mirror row_mask:0xf bank_mask:0xf
  v_add_f32_dpp v29, v29, v29 row_half_mirror row_mask:0xf bank_mask:0xf
  v_add_f32_dpp v30, v30, v30 row_half_mirror row_mask:0xf bank_mask:0xf
  v_add_f32_dpp v31, v31, v31 row_half_mirror row_mask:0xf bank_mask:0xf
  v_mul_f32 v32, 0xbfb8aa3b, v16
  v_mul_f32 v33, 0xbfb8aa3b, v17
  v_mul_f32 v34, 0xbfb8aa3b, v18
  v_mul_f32 v35, 0xbfb8aa3b, v19
  v_mul_f32 v36, 0xbfb8aa3b, v20
  v_mul_f32 v37, 0xbfb8aa3b, v21
  v_mul_f32 v38, 0xbfb8aa3b, v22
  v_mul_f32 v39, 0xbfb8aa3b, v23
  v_exp_f32 v32, v32
  v_exp_f32 v33, v33
  v_exp_f32 v34, v34
  v_exp_f32 v35, v35
  v_exp_f32 v36, v36
  v_exp_f32 v37, v37
  v_exp_f32 v38, v38
  v_exp_f32 v39, v39
  v_add_f32 v32, 1.0, v32
  v_add_f32 v33, 1.0, v33
  v_add_f32 v34, 1.0, v34
  v_add_f32 v35, 1.0, v35
  v_add_f32 v36, 1.0, v36
  v_add_f32 v37, 1.0, v37
  v_add_f32 v38, 1.0, v38
  v_add_f32 v39, 1.0, v39
  v_rcp_f32 v32, v32
  v_rcp_f32 v33, v33
  v_rcp_f32 v34, v34
  v_rcp_f32 v35, v35
  v_rcp_f32 v36, v36
  v_rcp_f32 v37, v37
  v_rcp_f32 v38, v38
  v_rcp_f32 v39, v39
  v_mul_f32 v16, v16, v24
  v_mul_f32 v17, v17, v25
  v_mul_f32 v18, v18, v26
  v_mul_f32 v19, v19, v27
  v_mul_f32 v20, v20, v28
  v_mul_f32 v21, v21, v29
  v_mul_f32 v22, v22, v30
  v_mul_f32 v23, v23, v31
  v_mul_f32 v16, v16, v32
  v_mul_f32 v17, v17, v33
  v_mul_f32 v18, v18, v34
  v_mul_f32 v19, v19, v35
  v_mul_f32 v20, v20, v36
  v_mul_f32 v21, v21, v37
  v_mul_f32 v22, v22, v38
  v_mul_f32 v23, v23, v39
  v_sub_f32 v10, 1.0, v14
  v_sub_f32 v11, 1.0, v15
  v_mul_f32 v16, v16, v10
  v_mul_f32 v17, v17, v10
  v_mul_f32 v18, v18, v10
  v_mul_f32 v19, v19, v10
  v_mul_f32 v20, v20, v11
  v_mul_f32 v21, v21, v11
  v_mul_f32 v22, v22, v11
  v_mul_f32 v23, v23, v11
  v_lshrrev_b32 v9, 3, v0
  v_lshlrev_b32 v9, 4, v9
  v_mov_b32 v12, 0
  s_mov_b32 exec_lo, 0x1010101
  s_mov_b32 exec_hi, 0x1010101
  ds_write_b128 v9, v[16:19] offset:1408
  ds_write_b128 v9, v[20:23] offset:1536
  s_mov_b32 exec_lo, 0x1
  s_mov_b32 exec_hi, 0x0
  ds_write_b64 v12, v[14:15] offset:1664
  s_mov_b64 exec, -1
  s_waitcnt lgkmcnt(0)
  v_mov_b32 v8, 0
  v_mov_b32 v9, 1
  s_mov_b64 s[46:47], exec
  s_mov_b32 exec_lo, 0x1
  s_mov_b32 exec_hi, 0x0
  ds_add_u32 v8, v9 offset:1292
  s_mov_b64 exec, s[46:47]
  s_branch L_hrel
L_h3:
  v_lshlrev_b32 v9, 2, v0
  v_mov_b32 v8, 0
  ds_write_b32 v9, v8 offset:1280
  s_waitcnt lgkmcnt(0)
  s_barrier
  s_load_dword s78, s[76:77], 0
  s_mov_b32 s16, s76
  s_and_b32 s17, s77, 0xffff
  s_mov_b32 s18, 536870912
  s_mov_b32 s19, 0x20000
  s_waitcnt lgkmcnt(0)
  s_add_u32 s79, s78, 1
  s_mul_i32 s79, s79, 9
  s_mul_i32 s37, s79, 0x9E3779B1
  s_add_u32 s79, s79, s38
  s_mul_i32 s36, s79, 0x9E3779B1
  s_and_b32 s20, s36, 0xff
  s_bfe_u32 s21, s36, 0x80008
  s_bfe_u32 s22, s36, 0x80010
  s_lshr_b32 s23, s36, 24
  s_and_b32 s24, s37, 0xff
  s_bfe_u32 s25, s37, 0x80008
  s_bfe_u32 s26, s37, 0x80010
  s_lshr_b32 s27, s37, 24
  s_branch L_qgather
L_h3b:
  s_cmp_ge_u32 s2, 32
  s_cbranch_scc1 L_fin
  s_mov_b32 s12, s72
  s_and_b32 s13, s73, 0xffff
  s_mov_b32 s14, 2048
  s_mov_b32 s15, 0x20000
  s_waitcnt vmcnt(0)
  v_lshrrev_b32 v8, 3, v0
  v_lshlrev_b32 v8, 13, v8
  v_and_b32 v9, 7, v0
  v_lshl_add_u32 v48, v9, 4, v8
  v_add_u32 v49, 4096, v48
  s_lshr_b32 s82, s2, 3
  s_lshl_b32 s82, s82, 16
  s_lshl_b32 s83, s30, 7
  s_add_u32 s82, s82, s83
  s_add_u32 s82, s82, 524288
  v_lshlrev_b32 v8, 3, v0
  s_bfe_u32 s84, s2, 0x10002
  s_lshl_b32 s84, s84, 10
  s_lshr_b32 s83, s2, 3
  s_lshl_b32 s83, s83, 8
  s_add_u32 s84, s84, s83
  s_and_b32 s83, s2, 3
  s_lshl_b32 s83, s83, 6
  s_add_u32 s84, s84, s83
  s_add_u32 s85, s78, 1
  v_mov_b32 v5, s85
  v_mov_b32 v6, 0
  buffer_load_dwordx4 v[16:19], v48, s[16:19], s82 offen offset:0 sc1
  buffer_load_dwordx4 v[20:23], v48, s[16:19], s82 offen offset:1024 sc1
  buffer_load_dwordx4 v[24:27], v48, s[16:19], s82 offen offset:2048 sc1
  buffer_load_dwordx4 v[28:31], v48, s[16:19], s82 offen offset:3072 sc1
  buffer_load_dwordx4 v[32:35], v49, s[16:19], s82 offen offset:0 sc1
  buffer_load_dwordx4 v[36:39], v49, s[16:19], s82 offen offset:1024 sc1
  buffer_load_dwordx4 v[40:43], v49, s[16:19], s82 offen offset:2048 sc1
  buffer_load_dwordx4 v[44:47], v49, s[16:19], s82 offen offset:3072 sc1
  s_mov_b32 s79, 0
  v_mov_b32 v11, 0
  s_nop 1
L_lw_16:
  ds_read_b32 v10, v11 offset:1296
  s_waitcnt lgkmcnt(0)
  v_cmp_gt_u32 vcc, 4, v10
  s_nop 0
  s_cbranch_vccz L_lok_17
  s_sleep 2
  s_add_u32 s79, s79, 1
  s_cmp_lt_u32 s79, 960000
  s_cbranch_scc1 L_lw_16
L_lok_17:
  s_mov_b32 s79, 0
L_poll_18:
  buffer_load_dwordx4 v[16:19], v48, s[16:19], s82 offen offset:0 sc1
  buffer_load_dwordx4 v[20:23], v48, s[16:19], s82 offen offset:1024 sc1
  buffer_load_dwordx4 v[24:27], v48, s[16:19], s82 offen offset:2048 sc1
  buffer_load_dwordx4 v[28:31], v48, s[16:19], s82 offen offset:3072 sc1
  buffer_load_dwordx4 v[32:35], v49, s[16:19], s82 offen offset:0 sc1
  buffer_load_dwordx4 v[36:39], v49, s[16:19], s82 offen offset:1024 sc1
  buffer_load_dwordx4 v[40:43], v49, s[16:19], s82 offen offset:2048 sc1
  buffer_load_dwordx4 v[44:47], v49, s[16:19], s82 offen offset:3072 sc1
  s_waitcnt vmcnt(0)
  v_xor_b32 v16, s24, v16
  v_xor_b32 v17, s25, v17
  v_or_b32 v9, v16, v17
  v_xor_b32 v18, s26, v18
  v_xor_b32 v19, s27, v19
  v_or3_b32 v9, v9, v18, v19
  v_xor_b32 v20, s24, v20
  v_xor_b32 v21, s25, v21
  v_or3_b32 v9, v9, v20, v21
  v_xor_b32 v22, s26, v22
  v_xor_b32 v23, s27, v23
  v_or3_b32 v9, v9, v22, v23
  v_xor_b32 v24, s24, v24
  v_xor_b32 v25, s25, v25
  v_or3_b32 v9, v9, v24, v25
  v_xor_b32 v26, s26, v26
  v_xor_b32 v27, s27, v27
  v_or3_b32 v9, v9, v26, v27
  v_xor_b32 v28, s24, v28
  v_xor_b32 v29, s25, v29
  v_or3_b32 v9, v9, v28, v29
  v_xor_b32 v30, s26, v30
  v_xor_b32 v31, s27, v31
  v_or3_b32 v9, v9, v30, v31
  v_xor_b32 v32, s24, v32
  v_xor_b32 v33, s25, v33
  v_or3_b32 v9, v9, v32, v33
  v_xor_b32 v34, s26, v34
  v_xor_b32 v35, s27, v35
  v_or3_b32 v9, v9, v34, v35
  v_xor_b32 v36, s24, v36
  v_xor_b32 v37, s25, v37
  v_or3_b32 v9, v9, v36, v37
  v_xor_b32 v38, s26, v38
  v_xor_b32 v39, s27, v39
  v_or3_b32 v9, v9, v38, v39
  v_xor_b32 v40, s24, v40
  v_xor_b32 v41, s25, v41
  v_or3_b32 v9, v9, v40, v41
  v_xor_b32 v42, s26, v42
  v_xor_b32 v43, s27, v43
  v_or3_b32 v9, v9, v42, v43
  v_xor_b32 v44, s24, v44
  v_xor_b32 v45, s25, v45
  v_or3_b32 v9, v9, v44, v45
  v_xor_b32 v46, s26, v46
  v_xor_b32 v47, s27, v47
  v_or3_b32 v9, v9, v46, v47
  v_and_b32 v9, 0xff, v9
  v_cmp_ne_u32 vcc, 0, v9
  s_nop 0
  s_cbranch_vccz L_pok_19
  s_mov_b64 exec, vcc
  s_add_u32 s79, s79, 1
  s_cmp_lt_u32 s79, 60000
  s_cbranch_scc1 L_poll_18
L_pok_19:
  s_mov_b64 exec, -1
  v_add_f32 v16, v16, v32
  v_add_f32 v17, v17, v33
  v_add_f32 v18, v18, v34
  v_add_f32 v19, v19, v35
  v_add_f32 v20, v20, v36
  v_add_f32 v21, v21, v37
  v_add_f32 v22, v22, v38
  v_add_f32 v23, v23, v39
  v_add_f32 v24, v24, v40
  v_add_f32 v25, v25, v41
  v_add_f32 v26, v26, v42
  v_add_f32 v27, v27, v43
  v_add_f32 v28, v28, v44
  v_add_f32 v29, v29, v45
  v_add_f32 v30, v30, v46
  v_add_f32 v31, v31, v47
  v_add_f32 v16, v16, v24
  v_add_f32 v17, v17, v25
  v_add_f32 v18, v18, v26
  v_add_f32 v19, v19, v27
  v_add_f32 v20, v20, v28
  v_add_f32 v21, v21, v29
  v_add_f32 v22, v22, v30
  v_add_f32 v23, v23, v31
  v_add_f32 v16, v16, v20
  v_add_f32 v17, v17, v21
  v_add_f32 v18, v18, v22
  v_add_f32 v19, v19, v23
  v_add_f32_dpp v16, v16, v16 row_ror:8 row_mask:0xf bank_mask:0xf
  v_add_f32_dpp v17, v17, v17 row_ror:8 row_mask:0xf bank_mask:0xf
  v_add_f32_dpp v18, v18, v18 row_ror:8 row_mask:0xf bank_mask:0xf
  v_add_f32_dpp v19, v19, v19 row_ror:8 row_mask:0xf bank_mask:0xf
  v_mov_b32 v20, v16
  v_mov_b32 v21, v17
  v_mov_b32 v22, v18
  v_mov_b32 v23, v19
  v_permlane16_swap_b32 v16, v20
  v_permlane16_swap_b32 v17, v21
  v_permlane16_swap_b32 v18, v22
  v_permlane16_swap_b32 v19, v23
  v_add_f32 v16, v16, v20
  v_add_f32 v17, v17, v21
  v_add_f32 v18, v18, v22
  v_add_f32 v19, v19, v23
  v_mov_b32 v20, v16
  v_mov_b32 v21, v17
  v_mov_b32 v22, v18
  v_mov_b32 v23, v19
  v_permlane32_swap_b32 v16, v20
  v_permlane32_swap_b32 v17, v21
  v_permlane32_swap_b32 v18, v22
  v_permlane32_swap_b32 v19, v23
  v_add_f32 v16, v16, v20
  v_add_f32 v17, v17, v21
  v_add_f32 v18, v18, v22
  v_add_f32 v19, v19, v23
  v_cvt_pk_bf16_f32 v16, v16, v17
  v_cvt_pk_bf16_f32 v17, v18, v19
  s_mov_b32 exec_lo, 0xff
  s_mov_b32 exec_hi, 0x0
  buffer_store_dwordx2 v[16:17], v8, s[12:15], s84 offen
  s_cmp_lg_u32 s2, 0
  s_cbranch_scc1 L_noepoch
  s_mov_b32 exec_lo, 0x1
  s_mov_b32 exec_hi, 0x0
  buffer_store_dword v5, v6, s[16:19], 0 offen sc1
L_noepoch:
  s_mov_b64 exec, -1
  s_branch L_fin
L_cw:
  s_sub_u32 s84, s3, 12
  v_lshlrev_b32 v8, 15, v2
  v_lshl_add_u32 v8, v1, 4, v8
  v_lshlrev_b32 v9, 10, v2
  v_lshl_add_u32 v9, v1, 4, v9
  s_lshl_b32 s82, s30, 2
  s_add_u32 s82, s82, s84
  s_lshl_b32 s82, s82, 17
  s_lshl_b32 s83, s31, 10
  s_add_u32 s82, s82, s83
  s_bfe_u32 s85, s2, 0x20003
  s_lshl_b32 s85, s85, 8
  s_add_u32 s82, s82, s85
  s_lshl_b32 s79, s84, 3
  s_add_u32 s83, s28, s79
  s_lshl_b32 s83, s83, 10
  s_add_u32 s83, s83, s85
  s_waitcnt lgkmcnt(0)
  s_mov_b32 s4, s60
  s_and_b32 s5, s61, 0xffff
  s_mov_b32 s6, 4194304
  s_mov_b32 s7, 0x20000
  s_mov_b32 s8, s68
  s_and_b32 s9, s69, 0xffff
  s_mov_b32 s10, 1835008
  s_mov_b32 s11, 0x20000
  s_barrier
  s_load_dword s78, s[76:77], 0
  s_mov_b32 s16, s76
  s_and_b32 s17, s77, 0xffff
  s_mov_b32 s18, 536870912
  s_mov_b32 s19, 0x20000
  s_waitcnt lgkmcnt(0)
  s_add_u32 s79, s78, 1
  s_mul_i32 s79, s79, 9
  s_mul_i32 s37, s79, 0x9E3779B1
  s_add_u32 s79, s79, s38
  s_mul_i32 s36, s79, 0x9E3779B1
  s_and_b32 s20, s36, 0xff
  s_bfe_u32 s21, s36, 0x80008
  s_bfe_u32 s22, s36, 0x80010
  s_lshr_b32 s23, s36, 24
  s_and_b32 s24, s37, 0xff
  s_bfe_u32 s25, s37, 0x80008
  s_bfe_u32 s26, s37, 0x80010
  s_lshr_b32 s27, s37, 24
  v_mov_b32 v10, 0
  v_mov_b32 v11, 1
  s_mov_b64 s[46:47], exec
  s_mov_b32 exec_lo, 0x1
  s_mov_b32 exec_hi, 0x0
  ds_add_u32 v10, v11 offset:1280
  s_mov_b64 exec, s[46:47]
  s_mov_b32 s79, 0
  v_mov_b32 v11, 0
  s_nop 1
L_lw_21:
  ds_read_b32 v10, v11 offset:1304
  s_waitcnt lgkmcnt(0)
  v_cmp_gt_u32 vcc, 8, v10
  s_nop 0
  s_cbranch_vccz L_lok_22
  s_sleep 4
  s_add_u32 s79, s79, 1
  s_cmp_lt_u32 s79, 960000
  s_cbranch_scc1 L_lw_21
L_lok_22:
  buffer_load_dwordx4 v[16:19], v8, s[4:7], s82 offen nt
  s_add_u32 s82, s82, 8192
  buffer_load_dwordx4 v[20:23], v8, s[4:7], s82 offen nt
  s_add_u32 s82, s82, 8192
  buffer_load_dwordx4 v[24:27], v8, s[4:7], s82 offen nt
  s_add_u32 s82, s82, 8192
  buffer_load_dwordx4 v[28:31], v8, s[4:7], s82 offen nt
  buffer_load_dwordx4 v[32:35], v9, s[8:11], s83 offen nt
  s_add_u32 s83, s83, 4096
  buffer_load_dwordx4 v[36:39], v9, s[8:11], s83 offen nt
  v_and_b32 v8, 1, v1
  v_lshlrev_b32 v8, 7, v8
  v_lshrrev_b32 v9, 1, v1
  v_add_u32 v8, v8, v9
  v_lshlrev_b32 v8, 11, v8
  v_lshl_add_u32 v9, v2, 4, v8
  s_lshl_b32 s82, s30, 15
  s_lshl_b32 s83, s31, 8
  s_add_u32 s82, s82, s83
  s_lshl_b32 s79, s84, 6
  s_add_u32 s82, s82, s79
  s_add_u32 s82, s82, 1048576
  s_add_u32 s83, s82, 16384
  v_lshrrev_b32 v12, 1, v2
  v_lshlrev_b32 v12, 9, v12
  v_and_b32 v13, 1, v2
  v_lshl_add_u32 v12, v13, 4, v12
  v_lshl_add_u32 v12, v1, 5, v12
  s_lshl_b32 s79, s84, 10
  v_add_u32 v13, s79, v12
  s_bfe_u32 s40, s2, 0x20003
  s_lshl_b32 s40, s40, 6
  s_lshl_b32 s79, s30, 3
  s_add_u32 s40, s40, s79
  s_add_u32 s40, s40, s31
  s_lshl_b32 s40, s40, 10
  s_add_u32 s40, s40, 524288
  s_mov_b32 s42, 0
  v_mov_b32 v43, 0
  v_mov_b32 v47, 0
  v_mov_b32 v51, 0
  v_mov_b32 v55, 0
  v_mov_b32 v59, 0
  v_mov_b32 v63, 0
  v_mov_b32 v67, 0
  v_mov_b32 v71, 0
  s_mov_b32 s79, 0
  v_mov_b32 v11, 0
  s_nop 1
L_lw_23:
  ds_read_b32 v10, v11 offset:1292
  s_waitcnt lgkmcnt(0)
  v_cmp_gt_u32 vcc, 1, v10
  s_nop 0
  s_cbranch_vccz L_lok_24
  s_sleep 4
  s_add_u32 s79, s79, 1
  s_cmp_lt_u32 s79, 960000
  s_cbranch_scc1 L_lw_23
L_lok_24:
  v_and_b32 v8, 1, v1
  v_lshlrev_b32 v14, 2, v8
  v_lshlrev_b32 v8, 7, v8
  v_lshl_add_u32 v8, v2, 2, v8
  s_lshl_b32 s79, s84, 5
  v_add_u32 v8, s79, v8
  ds_read_b32 v10, v8 offset:1408
  ds_read_b32 v11, v8 offset:1424
  ds_read_b32 v118, v14 offset:1664
  v_lshlrev_b32 v8, 3, v2
  s_waitcnt lgkmcnt(0)
  v_cvt_pk_bf16_f32 v114, v10, v11
  v_mov_b32 v115, 0
  v_mov_b32 v14, 0
  v_mov_b32 v15, 1
  s_waitcnt vmcnt(0)
  buffer_load_dwordx4 v[104:107], v9, s[16:19], s82 offen sc1
  buffer_load_dwordx4 v[108:111], v9, s[16:19], s83 offen sc1
  v_perm_b32 v40, v20, v16, s80
  v_perm_b32 v44, v20, v16, s81
  v_perm_b32 v48, v21, v17, s80
  v_perm_b32 v52, v21, v17, s81
  v_perm_b32 v56, v22, v18, s80
  v_perm_b32 v60, v22, v18, s81
  v_perm_b32 v64, v23, v19, s80
  v_perm_b32 v68, v23, v19, s81
  v_perm_b32 v41, v28, v24, s80
  v_perm_b32 v45, v28, v24, s81
  v_perm_b32 v49, v29, v25, s80
  v_perm_b32 v53, v29, v25, s81
  v_perm_b32 v57, v30, v26, s80
  v_perm_b32 v61, v30, v26, s81
  v_perm_b32 v65, v31, v27, s80
  v_perm_b32 v69, v31, v27, s81
  v_perm_b32 v42, v36, v32, s80
  v_perm_b32 v46, v36, v32, s81
  v_perm_b32 v50, v37, v33, s80
  v_perm_b32 v54, v37, v33, s81
  v_perm_b32 v58, v38, v34, s80
  v_perm_b32 v62, v38, v34, s81
  v_perm_b32 v66, v39, v35, s80
  v_perm_b32 v70, v39, v35, s81
  s_mov_b32 s79, 0
  s_nop 0
  s_branch L_pwt_27
L_poll_25:
  buffer_load_dwordx4 v[104:107], v9, s[16:19], s82 offen sc1
  buffer_load_dwordx4 v[108:111], v9, s[16:19], s83 offen sc1
L_pwt_27:
  s_waitcnt vmcnt(0)
  v_xor_b32 v104, s20, v104
  v_xor_b32 v105, s21, v105
  v_or_b32 v5, v104, v105
  v_xor_b32 v106, s22, v106
  v_xor_b32 v107, s23, v107
  v_or3_b32 v5, v5, v106, v107
  v_xor_b32 v108, s20, v108
  v_xor_b32 v109, s21, v109
  v_or3_b32 v5, v5, v108, v109
  v_xor_b32 v110, s22, v110
  v_xor_b32 v111, s23, v111
  v_or3_b32 v5, v5, v110, v111
  v_and_b32 v5, 0xff, v5
  v_cmp_ne_u32 vcc, 0, v5
  s_nop 0
  s_cbranch_vccz L_pok_26
  s_mov_b64 exec, vcc
  s_add_u32 s79, s79, 1
  s_cmp_lt_u32 s79, 150
  s_cbranch_scc1 L_poll_25
  s_branch L_slow_28
L_pok_26:
  s_mov_b64 exec, -1
  v_bfe_u32 v116, v104, 8, 2
  v_bfe_u32 v5, v105, 8, 2
  v_bfe_u32 v6, v106, 8, 2
  v_bfe_u32 v7, v107, 8, 2
  v_lshl_or_b32 v116, v5, 2, v116
  v_lshl_or_b32 v6, v7, 2, v6
  v_lshl_or_b32 v116, v6, 4, v116
  v_lshlrev_b32 v116, v8, v116
  v_bfe_u32 v117, v108, 8, 2
  v_bfe_u32 v5, v109, 8, 2
  v_bfe_u32 v6, v110, 8, 2
  v_bfe_u32 v7, v111, 8, 2
  v_lshl_or_b32 v117, v5, 2, v117
  v_lshl_or_b32 v6, v7, 2, v6
  v_lshl_or_b32 v117, v6, 4, v117
  v_lshlrev_b32 v117, v8, v117
  v_mov_b32 v5, v116
  v_mov_b32 v6, v117
  s_nop 0
  v_permlane16_swap_b32 v116, v5
  v_permlane16_swap_b32 v117, v6
  v_or_b32 v116, v116, v5
  v_or_b32 v117, v117, v6
  v_mov_b32 v5, v116
  v_mov_b32 v6, v117
  s_nop 0
  v_permlane32_swap_b32 v116, v5
  v_permlane32_swap_b32 v117, v6
  v_or_b32 v116, v116, v5
  v_or_b32 v117, v117, v6
  v_max_f32 v5, v116, v117
  s_nop 1
  v_max_f32_dpp v5, v5, v5 row_ror:8 row_mask:0xf bank_mask:0xf
  s_nop 1
  v_max_f32_dpp v5, v5, v5 row_ror:4 row_mask:0xf bank_mask:0xf
  s_nop 1
  v_max_f32_dpp v5, v5, v5 row_ror:2 row_mask:0xf bank_mask:0xf
  v_sub_f32 v116, v116, v5
  v_sub_f32 v117, v117, v5
  v_exp_f32 v116, v116
  v_exp_f32 v117, v117
  s_nop 0
  v_add_f32 v6, v116, v117
  v_mul_f32 v104, v116, v104
  v_mul_f32 v105, v116, v105
  v_mul_f32 v106, v116, v106
  v_mul_f32 v107, v116, v107
  v_fmac_f32 v104, v117, v108
  v_fmac_f32 v105, v117, v109
  v_fmac_f32 v106, v117, v110
  v_fmac_f32 v107, v117, v111
  v_add_f32_dpp v6, v6, v6 row_ror:8 row_mask:0xf bank_mask:0xf
  v_add_f32_dpp v104, v104, v104 row_ror:8 row_mask:0xf bank_mask:0xf
  v_add_f32_dpp v105, v105, v105 row_ror:8 row_mask:0xf bank_mask:0xf
  v_add_f32_dpp v106, v106, v106 row_ror:8 row_mask:0xf bank_mask:0xf
  v_add_f32_dpp v107, v107, v107 row_ror:8 row_mask:0xf bank_mask:0xf
  v_add_f32_dpp v6, v6, v6 row_ror:4 row_mask:0xf bank_mask:0xf
  v_add_f32_dpp v104, v104, v104 row_ror:4 row_mask:0xf bank_mask:0xf
  v_add_f32_dpp v105, v105, v105 row_ror:4 row_mask:0xf bank_mask:0xf
  v_add_f32_dpp v106, v106, v106 row_ror:4 row_mask:0xf bank_mask:0xf
  v_add_f32_dpp v107, v107, v107 row_ror:4 row_mask:0xf bank_mask:0xf
  v_add_f32_dpp v6, v6, v6 row_ror:2 row_mask:0xf bank_mask:0xf
  v_add_f32_dpp v104, v104, v104 row_ror:2 row_mask:0xf bank_mask:0xf
  v_add_f32_dpp v105, v105, v105 row_ror:2 row_mask:0xf bank_mask:0xf
  v_add_f32_dpp v106, v106, v106 row_ror:2 row_mask:0xf bank_mask:0xf
  v_add_f32_dpp v107, v107, v107 row_ror:2 row_mask:0xf bank_mask:0xf
  v_rcp_f32 v6, v6
  s_nop 0
  v_mul_f32 v6, v6, v118
  v_mul_f32 v104, v6, v104
  v_mul_f32 v105, v6, v105
  v_mul_f32 v106, v6, v106
  v_mul_f32 v107, v6, v107
  v_cvt_pk_bf16_f32 v112, v104, v105
  v_cvt_pk_bf16_f32 v113, v106, v107
  s_nop 1
  v_mfma_f32_16x16x32_bf16 v[72:75], v[112:115], v[40:43], 0
  v_mfma_f32_16x16x32_bf16 v[76:79], v[112:115], v[44:47], 0
  v_mfma_f32_16x16x32_bf16 v[80:83], v[112:115], v[48:51], 0
  v_mfma_f32_16x16x32_bf16 v[84:87], v[112:115], v[52:55], 0
  v_mfma_f32_16x16x32_bf16 v[88:91], v[112:115], v[56:59], 0
  v_mfma_f32_16x16x32_bf16 v[92:95], v[112:115], v[60:63], 0
  v_mfma_f32_16x16x32_bf16 v[96:99], v[112:115], v[64:67], 0
  v_mfma_f32_16x16x32_bf16 v[100:103], v[112:115], v[68:71], 0
  s_mov_b32 exec_lo, 0xffff
  s_mov_b32 exec_hi, 0x0
  v_mov_b32 v16, v72
  v_mov_b32 v17, v76
  v_mov_b32 v18, v80
  v_mov_b32 v19, v84
  s_mov_b32 exec_lo, 0x0
  s_mov_b32 exec_hi, 0xffff
  v_mov_b32 v16, v73
  v_mov_b32 v17, v77
  v_mov_b32 v18, v81
  v_mov_b32 v19, v85
  s_mov_b32 exec_lo, 0xffff0000
  s_mov_b32 exec_hi, 0x0
  v_mov_b32 v16, v88
  v_mov_b32 v17, v92
  v_mov_b32 v18, v96
  v_mov_b32 v19, v100
  s_mov_b32 exec_lo, 0x0
  s_mov_b32 exec_hi, 0xffff0000
  v_mov_b32 v16, v89
  v_mov_b32 v17, v93
  v_mov_b32 v18, v97
  v_mov_b32 v19, v101
  s_mov_b64 exec, -1
  ds_write_b128 v13, v[16:19] offset:2048
  s_mov_b32 exec_lo, 0x1
  s_mov_b32 exec_hi, 0x0
  ds_add_rtn_u32 v15, v14, v15 offset:1296
  s_mov_b64 exec, -1
  ds_read_b128 v[20:23], v12 offset:2048
  ds_read_b128 v[24:27], v12 offset:3072
  ds_read_b128 v[28:31], v12 offset:4096
  ds_read_b128 v[32:35], v12 offset:5120
  s_waitcnt lgkmcnt(4)
  v_readfirstlane_b32 s79, v15
  s_cmp_lg_u32 s79, 3
  s_nop 3
  s_cbranch_scc1 L_crel
  s_waitcnt lgkmcnt(0)
  v_add_f32 v20, v20, v24
  v_add_f32 v28, v28, v32
  v_add_f32 v21, v21, v25
  v_add_f32 v29, v29, v33
  v_add_f32 v22, v22, v26
  v_add_f32 v30, v30, v34
  v_add_f32 v23, v23, v27
  v_add_f32 v31, v31, v35
  v_add_f32 v20, v20, v28
  v_add_f32 v21, v21, v29
  v_add_f32 v22, v22, v30
  v_add_f32 v23, v23, v31
  v_and_or_b32 v20, v20, v3, s24
  v_and_or_b32 v21, v21, v3, s25
  v_and_or_b32 v22, v22, v3, s26
  v_and_or_b32 v23, v23, v3, s27
  buffer_store_dwordx4 v[20:23], v12, s[16:19], s40 offen sc1
  s_nop 1
L_crel:
  s_cmp_eq_u32 s42, 1
  s_cbranch_scc1 L_fin
  v_mov_b32 v5, 0
  v_mov_b32 v6, 1
  s_mov_b64 s[46:47], exec
  s_mov_b32 exec_lo, 0x1
  s_mov_b32 exec_hi, 0x0
  ds_max_u32 v5, v6 offset:1308
  s_mov_b64 exec, s[46:47]
  s_branch L_fin
L_attn:
  s_sub_u32 s84, s3, 4
  s_and_b32 s82, s2, 15
  s_lshr_b32 s83, s2, 4
  s_lshl_b32 s85, s82, 4
  s_add_u32 s85, s85, s83
  s_lshl_b32 s82, s82, 23
  s_add_u32 s82, s82, 0x700000
  s_lshl_b32 s83, s83, 16
  s_add_u32 s82, s82, s83
  s_lshl_b32 s83, s84, 13
  s_add_u32 s82, s82, s83
  s_add_u32 s83, s82, 4096
  v_lshlrev_b32 v5, 8, v1
  v_lshl_add_u32 v5, v2, 4, v5
  v_lshlrev_b32 v6, 10, v2
  v_lshl_add_u32 v6, v1, 4, v6
  s_waitcnt lgkmcnt(0)
  s_mov_b32 s4, s54
  s_and_b32 s5, s55, 0xffff
  s_mov_b32 s6, 134217728
  s_mov_b32 s7, 0x20000
  s_mov_b32 s8, s56
  s_and_b32 s9, s57, 0xffff
  s_mov_b32 s10, 134217728
  s_mov_b32 s11, 0x20000
  s_barrier
  buffer_load_dwordx4 v[16:19], v5, s[4:7], s82 offen offset:0 nt
  buffer_load_dwordx4 v[20:23], v5, s[4:7], s82 offen offset:64 nt
  buffer_load_dwordx4 v[24:27], v5, s[4:7], s82 offen offset:128 nt
  buffer_load_dwordx4 v[28:31], v5, s[4:7], s82 offen offset:192 nt
  buffer_load_dwordx4 v[32:35], v5, s[4:7], s83 offen offset:0 nt
  buffer_load_dwordx4 v[36:39], v5, s[4:7], s83 offen offset:64 nt
  buffer_load_dwordx4 v[40:43], v5, s[4:7], s83 offen offset:128 nt
  buffer_load_dwordx4 v[44:47], v5, s[4:7], s83 offen offset:192 nt
  v_mov_b32 v8, 0
  v_mov_b32 v9, 1
  s_mov_b64 s[46:47], exec
  s_mov_b32 exec_lo, 0x1
  s_mov_b32 exec_hi, 0x0
  ds_add_u32 v8, v9 offset:1300
  s_mov_b64 exec, s[46:47]
  s_load_dword s78, s[76:77], 0
  s_mov_b32 s16, s76
  s_and_b32 s17, s77, 0xffff
  s_mov_b32 s18, 536870912
  s_mov_b32 s19, 0x20000
  s_mov_b32 s79, 0
  v_mov_b32 v9, 0
  s_nop 1
L_lw_29:
  ds_read_b32 v8, v9 offset:1300
  s_waitcnt lgkmcnt(0)
  v_cmp_gt_u32 vcc, 8, v8
  s_nop 0
  s_cbranch_vccz L_lok_30
  s_sleep 1
  s_add_u32 s79, s79, 1
  s_cmp_lt_u32 s79, 960000
  s_cbranch_scc1 L_lw_29
L_lok_30:
  buffer_load_dwordx4 v[48:51], v6, s[8:11], s82 offen offset:0 nt
  buffer_load_dwordx4 v[52:55], v6, s[8:11], s82 offen offset:256 nt
  buffer_load_dwordx4 v[56:59], v6, s[8:11], s82 offen offset:512 nt
  buffer_load_dwordx4 v[60:63], v6, s[8:11], s82 offen offset:768 nt
  buffer_load_dwordx4 v[64:67], v6, s[8:11], s83 offen offset:0 nt
  buffer_load_dwordx4 v[68:71], v6, s[8:11], s83 offen offset:256 nt
  buffer_load_dwordx4 v[72:75], v6, s[8:11], s83 offen offset:512 nt
  buffer_load_dwordx4 v[76:79], v6, s[8:11], s83 offen offset:768 nt
  v_mov_b32 v8, 0
  v_mov_b32 v9, 1
  s_mov_b64 s[46:47], exec
  s_mov_b32 exec_lo, 0x1
  s_mov_b32 exec_hi, 0x0
  ds_add_u32 v8, v9 offset:1304
  s_mov_b64 exec, s[46:47]
  s_waitcnt lgkmcnt(0)
  s_add_u32 s79, s78, 1
  s_mul_i32 s79, s79, 9
  s_mul_i32 s37, s79, 0x9E3779B1
  s_add_u32 s79, s79, s38
  s_mul_i32 s36, s79, 0x9E3779B1
  s_and_b32 s20, s36, 0xff
  s_bfe_u32 s21, s36, 0x80008
  s_bfe_u32 s22, s36, 0x80010
  s_lshr_b32 s23, s36, 24
  s_and_b32 s24, s37, 0xff
  s_bfe_u32 s25, s37, 0x80008
  s_bfe_u32 s26, s37, 0x80010
  s_lshr_b32 s27, s37, 24
  v_and_b32 v6, 3, v1
  v_lshlrev_b32 v6, 8, v6
  v_lshl_add_u32 v6, v2, 4, v6
  s_mov_b32 s42, 0
  v_lshlrev_b32 v13, 6, v1
  v_lshl_add_u32 v13, v2, 4, v13
  s_lshl_b32 s79, s84, 11
  v_add_u32 v13, s79, v13
  v_lshlrev_b32 v5, 2, v0
  s_lshl_b32 s79, s84, 8
  v_add_u32 v5, s79, v5
  v_mov_b32 v7, 0xfffffc00
  s_lshl_b32 s41, s85, 11
  s_add_u32 s41, s41, 1048576
  v_and_b32 v14, 3, v0
  v_lshlrev_b32 v14, 3, v14
  v_lshrrev_b32 v15, v14, s37
  v_lshrrev_b32 v14, v14, s36
  v_and_b32 v14, 0xff, v14
  v_and_b32 v15, 0xff, v15
  s_mov_b32 s79, 0
  v_mov_b32 v9, 0
  s_nop 1
L_lw_31:
  ds_read_b32 v8, v9 offset:1280
  s_waitcnt lgkmcnt(0)
  v_cmp_gt_u32 vcc, 8, v8
  s_nop 0
  s_cbranch_vccz L_lok_32
  s_sleep 2
  s_add_u32 s79, s79, 1
  s_cmp_lt_u32 s79, 960000
  s_cbranch_scc1 L_lw_31
L_lok_32:
  ds_read_b128 v[80:83], v6 offset:0
  ds_read_b128 v[84:87], v6 offset:64
  ds_read_b128 v[88:91], v6 offset:128
  ds_read_b128 v[92:95], v6 offset:192
  s_waitcnt vmcnt(8) lgkmcnt(0)
  v_mfma_f32_16x16x32_bf16 v[96:99], v[16:19], v[80:83], 0
  v_mfma_f32_16x16x32_bf16 v[100:103], v[32:35], v[80:83], 0
  v_mfma_f32_16x16x32_bf16 v[96:99], v[20:23], v[84:87], v[96:99]
  v_mfma_f32_16x16x32_bf16 v[100:103], v[36:39], v[84:87], v[100:103]
  v_mfma_f32_16x16x32_bf16 v[96:99], v[24:27], v[88:91], v[96:99]
  v_mfma_f32_16x16x32_bf16 v[100:103], v[40:43], v[88:91], v[100:103]
  v_mfma_f32_16x16x32_bf16 v[96:99], v[28:31], v[92:95], v[96:99]
  v_mfma_f32_16x16x32_bf16 v[100:103], v[44:47], v[92:95], v[100:103]
  s_mov_b32 s79, 0x3e0293ee
  s_nop 5
  v_mul_f32 v96, s79, v96
  v_mul_f32 v97, s79, v97
  v_mul_f32 v98, s79, v98
  v_mul_f32 v99, s79, v99
  v_mul_f32 v100, s79, v100
  v_mul_f32 v101, s79, v101
  v_mul_f32 v102, s79, v102
  v_mul_f32 v103, s79, v103
  v_max3_f32 v8, v96, v97, v98
  v_max3_f32 v8, v8, v99, v100
  v_max3_f32 v8, v8, v101, v102
  v_max_f32 v8, v8, v103
  v_mov_b32 v10, v8
  s_nop 1
  v_permlane16_swap_b32 v8, v10
  v_max_f32 v8, v8, v10
  v_mov_b32 v10, v8
  s_nop 1
  v_permlane32_swap_b32 v8, v10
  v_max_f32 v8, v8, v10
  v_sub_f32 v96, v96, v8
  v_sub_f32 v97, v97, v8
  v_sub_f32 v98, v98, v8
  v_sub_f32 v99, v99, v8
  v_sub_f32 v100, v100, v8
  v_sub_f32 v101, v101, v8
  v_sub_f32 v102, v102, v8
  v_sub_f32 v103, v103, v8
  v_exp_f32 v96, v96
  v_exp_f32 v97, v97
  v_exp_f32 v98, v98
  v_exp_f32 v99, v99
  v_exp_f32 v100, v100
  v_exp_f32 v101, v101
  v_exp_f32 v102, v102
  v_exp_f32 v103, v103
  v_add_f32 v9, v96, v97
  v_add_f32 v9, v9, v98
  v_add_f32 v9, v9, v99
  v_add_f32 v9, v9, v100
  v_add_f32 v9, v9, v101
  v_add_f32 v9, v9, v102
  v_add_f32 v9, v9, v103
  v_cvt_pk_bf16_f32 v104, v96, v97
  v_cvt_pk_bf16_f32 v105, v98, v99
  v_cvt_pk_bf16_f32 v106, v100, v101
  v_cvt_pk_bf16_f32 v107, v102, v103
  v_mov_b32 v10, v9
  s_nop 1
  v_permlane16_swap_b32 v9, v10
  v_add_f32 v9, v9, v10
  v_mov_b32 v10, v9
  s_nop 1
  v_permlane32_swap_b32 v9, v10
  v_add_f32 v9, v9, v10
  v_lshlrev_b32 v10, 3, v0
  s_lshl_b32 s79, s84, 5
  v_add_u32 v10, s79, v10
  s_mov_b32 exec_lo, 0xf
  s_mov_b32 exec_hi, 0x0
  ds_write_b64 v10, v[8:9] offset:1024
  s_mov_b64 exec, -1
  s_waitcnt lgkmcnt(0)
  v_mov_b32 v10, 0
  v_mov_b32 v11, 1
  s_mov_b64 s[46:47], exec
  s_mov_b32 exec_lo, 0x1
  s_mov_b32 exec_hi, 0x0
  ds_add_u32 v10, v11 offset:1284
  s_mov_b64 exec, s[46:47]
  s_mov_b32 s79, 0
  v_mov_b32 v11, 0
  s_nop 1
L_lw_33:
  ds_read_b32 v10, v11 offset:1284
  s_waitcnt lgkmcnt(0)
  v_cmp_gt_u32 vcc, 8, v10
  s_nop 0
  s_cbranch_vccz L_lok_34
  s_sleep 1
  s_add_u32 s79, s79, 1
  s_cmp_lt_u32 s79, 960000
  s_cbranch_scc1 L_lw_33
L_lok_34:
  v_lshlrev_b32 v8, 3, v2
  ds_read_b64 v[80:81], v8 offset:1024
  ds_read_b64 v[82:83], v8 offset:1056
  ds_read_b64 v[84:85], v8 offset:1088
  ds_read_b64 v[86:87], v8 offset:1120
  ds_read_b64 v[88:89], v8 offset:1152
  ds_read_b64 v[90:91], v8 offset:1184
  ds_read_b64 v[92:93], v8 offset:1216
  ds_read_b64 v[94:95], v8 offset:1248
  s_waitcnt lgkmcnt(0)
  v_max3_f32 v9, v80, v82, v84
  v_max3_f32 v9, v9, v86, v88
  v_max3_f32 v9, v9, v90, v92
  v_max_f32 v9, v9, v94
  v_sub_f32 v108, v80, v9
  v_sub_f32 v109, v82, v9
  v_sub_f32 v110, v84, v9
  v_sub_f32 v111, v86, v9
  v_sub_f32 v112, v88, v9
  v_sub_f32 v113, v90, v9
  v_sub_f32 v114, v92, v9
  v_sub_f32 v115, v94, v9
  v_exp_f32 v108, v108
  v_exp_f32 v109, v109
  v_exp_f32 v110, v110
  v_exp_f32 v111, v111
  v_exp_f32 v112, v112
  v_exp_f32 v113, v113
  v_exp_f32 v114, v114
  v_exp_f32 v115, v115
  v_mul_f32 v117, v108, v81
  v_fmac_f32 v117, v109, v83
  v_fmac_f32 v117, v110, v85
  v_fmac_f32 v117, v111, v87
  v_fmac_f32 v117, v112, v89
  v_fmac_f32 v117, v113, v91
  v_fmac_f32 v117, v114, v93
  v_fmac_f32 v117, v115, v95
  v_log_f32 v116, v117
  v_rcp_f32 v117, v117
  v_add_f32 v116, v116, v9
  v_lshlrev_b32 v8, 1, v1
  v_lshrrev_b32 v116, v8, v116
  v_and_b32 v116, 3, v116
  v_lshl_or_b32 v116, v116, 8, v14
  s_mov_b32 s42, 1
  v_mul_f32 v108, v108, v117
  v_mul_f32 v109, v109, v117
  v_mul_f32 v110, v110, v117
  v_mul_f32 v111, v111, v117
  v_mul_f32 v112, v112, v117
  v_mul_f32 v113, v113, v117
  v_mul_f32 v114, v114, v117
  v_mul_f32 v115, v115, v117
  v_mov_b32 v10, 0
  v_mov_b32 v11, 1
  s_waitcnt vmcnt(6)
  v_perm_b32 v16, v52, v48, s80
  v_perm_b32 v20, v52, v48, s81
  v_perm_b32 v24, v53, v49, s80
  v_perm_b32 v28, v53, v49, s81
  v_perm_b32 v32, v54, v50, s80
  v_perm_b32 v36, v54, v50, s81
  v_perm_b32 v40, v55, v51, s80
  v_perm_b32 v44, v55, v51, s81
  s_waitcnt vmcnt(4)
  v_perm_b32 v17, v60, v56, s80
  v_perm_b32 v21, v60, v56, s81
  v_perm_b32 v25, v61, v57, s80
  v_perm_b32 v29, v61, v57, s81
  v_perm_b32 v33, v62, v58, s80
  v_perm_b32 v37, v62, v58, s81
  v_perm_b32 v41, v63, v59, s80
  v_perm_b32 v45, v63, v59, s81
  s_waitcnt vmcnt(2)
  v_perm_b32 v18, v68, v64, s80
  v_perm_b32 v22, v68, v64, s81
  v_perm_b32 v26, v69, v65, s80
  v_perm_b32 v30, v69, v65, s81
  v_perm_b32 v34, v70, v66, s80
  v_perm_b32 v38, v70, v66, s81
  v_perm_b32 v42, v71, v67, s80
  v_perm_b32 v46, v71, v67, s81
  s_waitcnt vmcnt(0)
  v_perm_b32 v19, v76, v72, s80
  v_perm_b32 v23, v76, v72, s81
  v_perm_b32 v27, v77, v73, s80
  v_perm_b32 v31, v77, v73, s81
  v_mfma_f32_16x16x32_bf16 v[48:51], v[16:19], v[104:107], 0
  v_perm_b32 v35, v78, v74, s80
  v_mfma_f32_16x16x32_bf16 v[52:55], v[20:23], v[104:107], 0
  v_perm_b32 v39, v78, v74, s81
  v_mfma_f32_16x16x32_bf16 v[56:59], v[24:27], v[104:107], 0
  v_perm_b32 v43, v79, v75, s80
  v_mfma_f32_16x16x32_bf16 v[60:63], v[28:31], v[104:107], 0
  v_perm_b32 v47, v79, v75, s81
  s_mov_b32 exec_lo, 0xf000f
  s_mov_b32 exec_hi, 0xf000f
  v_mfma_f32_16x16x32_bf16 v[64:67], v[32:35], v[104:107], 0
  v_mfma_f32_16x16x32_bf16 v[68:71], v[36:39], v[104:107], 0
  v_mfma_f32_16x16x32_bf16 v[120:123], v[40:43], v[104:107], 0
  v_mfma_f32_16x16x32_bf16 v[124:127], v[44:47], v[104:107], 0
  ds_write_b128 v13, v[48:51] offset:6144
  ds_write_b128 v13, v[52:55] offset:6400
  ds_write_b128 v13, v[56:59] offset:6656
  ds_write_b128 v13, v[60:63] offset:6912
  s_nop 0
  ds_write_b128 v13, v[64:67] offset:7168
  ds_write_b128 v13, v[68:71] offset:7424
  ds_write_b128 v13, v[120:123] offset:7680
  ds_write_b128 v13, v[124:127] offset:7936
  s_mov_b32 exec_lo, 0x1
  s_mov_b32 exec_hi, 0x0
  ds_add_u32 v10, v11 offset:1288
  s_mov_b64 exec, -1
  s_mov_b32 s79, 0
  v_mov_b32 v9, 0
  s_nop 1
L_lw_35:
  ds_read_b32 v8, v9 offset:1288
  s_waitcnt lgkmcnt(0)
  v_cmp_gt_u32 vcc, 8, v8
  s_nop 0
  s_cbranch_vccz L_lok_36
  s_add_u32 s79, s79, 1
  s_cmp_lt_u32 s79, 960000
  s_cbranch_scc1 L_lw_35
L_lok_36:
  ds_read_b32 v80, v5 offset:6144
  ds_read_b32 v81, v5 offset:8192
  ds_read_b32 v82, v5 offset:10240
  ds_read_b32 v83, v5 offset:12288
  ds_read_b32 v84, v5 offset:14336
  ds_read_b32 v85, v5 offset:16384
  ds_read_b32 v86, v5 offset:18432
  ds_read_b32 v87, v5 offset:20480
  s_waitcnt lgkmcnt(7)
  v_mul_f32 v12, v108, v80
  s_waitcnt lgkmcnt(6)
  v_fmac_f32 v12, v109, v81
  s_waitcnt lgkmcnt(5)
  v_fmac_f32 v12, v110, v82
  s_waitcnt lgkmcnt(4)
  v_fmac_f32 v12, v111, v83
  s_waitcnt lgkmcnt(3)
  v_fmac_f32 v12, v112, v84
  s_waitcnt lgkmcnt(2)
  v_fmac_f32 v12, v113, v85
  s_waitcnt lgkmcnt(1)
  v_fmac_f32 v12, v114, v86
  s_waitcnt lgkmcnt(0)
  v_fmac_f32 v12, v115, v87
  v_and_or_b32 v12, v12, v7, v116
  buffer_store_dword v12, v5, s[16:19], s41 offen
  s_mov_b32 s79, 0
  v_mov_b32 v11, 0
  s_nop 1
L_rw_37:
  s_sleep 8
  ds_read_b32 v10, v11 offset:1308
  s_waitcnt lgkmcnt(0)
  v_readfirstlane_b32 s43, v10
  s_cmp_eq_u32 s43, 1
  s_nop 3
  s_cbranch_scc1 L_fin
  s_cmp_eq_u32 s43, 2
  s_cbranch_scc1 L_rs_38
  s_add_u32 s79, s79, 1
  s_cmp_lt_u32 s79, 120
  s_cbranch_scc1 L_rw_37
  v_mov_b32 v10, 0
  v_mov_b32 v11, 2
  s_mov_b64 s[46:47], exec
  s_mov_b32 exec_lo, 0x1
  s_mov_b32 exec_hi, 0x0
  ds_max_u32 v10, v11 offset:1308
  s_mov_b64 exec, s[46:47]
L_rs_38:
  v_and_or_b32 v12, v12, v3, v15
  buffer_store_dword v12, v5, s[16:19], s41 offen sc1
  s_nop 0
  s_branch L_fin
L_slow_6:
  s_mov_b64 s[44:45], exec
  s_mov_b64 exec, -1
  v_mov_b32 v8, 0
  v_mov_b32 v9, 2
  s_mov_b64 s[46:47], exec
  s_mov_b32 exec_lo, 0x1
  s_mov_b32 exec_hi, 0x0
  ds_max_u32 v8, v9 offset:1308
  s_mov_b64 exec, s[46:47]
  s_mov_b64 exec, s[44:45]
  s_mov_b32 s79, 0
L_sp_39:
  buffer_load_dwordx4 v[16:19], v4, s[16:19], s82 offen offset:0 sc1
  buffer_load_dwordx4 v[20:23], v4, s[16:19], s82 offen offset:1024 sc1
  buffer_load_dwordx4 v[24:27], v4, s[16:19], s83 offen offset:0 sc1
  buffer_load_dwordx4 v[28:31], v4, s[16:19], s83 offen offset:1024 sc1
  buffer_load_dwordx4 v[32:35], v4, s[16:19], s84 offen offset:0 sc1
  buffer_load_dwordx4 v[36:39], v4, s[16:19], s84 offen offset:1024 sc1
  buffer_load_dwordx4 v[40:43], v4, s[16:19], s85 offen offset:0 sc1
  buffer_load_dwordx4 v[44:47], v4, s[16:19], s85 offen offset:1024 sc1
  s_waitcnt vmcnt(0)
  v_mov_b32 v8, 0
  v_xor_b32 v9, s20, v16
  v_xor_b32 v10, s21, v17
  v_or_b32 v11, v9, v10
  v_xor_b32 v9, s22, v18
  v_xor_b32 v10, s23, v19
  v_or3_b32 v11, v11, v9, v10
  v_and_b32 v11, 0xff, v11
  v_xor_b32 v9, s24, v16
  v_xor_b32 v10, s25, v17
  v_or_b32 v12, v9, v10
  v_xor_b32 v9, s26, v18
  v_xor_b32 v10, s27, v19
  v_or3_b32 v12, v12, v9, v10
  v_and_b32 v12, 0xff, v12
  v_min_u32 v11, v11, v12
  v_or_b32 v8, v8, v11
  v_xor_b32 v9, s20, v20
  v_xor_b32 v10, s21, v21
  v_or_b32 v11, v9, v10
  v_xor_b32 v9, s22, v22
  v_xor_b32 v10, s23, v23
  v_or3_b32 v11, v11, v9, v10
  v_and_b32 v11, 0xff, v11
  v_xor_b32 v9, s24, v20
  v_xor_b32 v10, s25, v21
  v_or_b32 v12, v9, v10
  v_xor_b32 v9, s26, v22
  v_xor_b32 v10, s27, v23
  v_or3_b32 v12, v12, v9, v10
  v_and_b32 v12, 0xff, v12
  v_min_u32 v11, v11, v12
  v_or_b32 v8, v8, v11
  v_xor_b32 v9, s20, v24
  v_xor_b32 v10, s21, v25
  v_or_b32 v11, v9, v10
  v_xor_b32 v9, s22, v26
  v_xor_b32 v10, s23, v27
  v_or3_b32 v11, v11, v9, v10
  v_and_b32 v11, 0xff, v11
  v_xor_b32 v9, s24, v24
  v_xor_b32 v10, s25, v25
  v_or_b32 v12, v9, v10
  v_xor_b32 v9, s26, v26
  v_xor_b32 v10, s27, v27
  v_or3_b32 v12, v12, v9, v10
  v_and_b32 v12, 0xff, v12
  v_min_u32 v11, v11, v12
  v_or_b32 v8, v8, v11
  v_xor_b32 v9, s20, v28
  v_xor_b32 v10, s21, v29
  v_or_b32 v11, v9, v10
  v_xor_b32 v9, s22, v30
  v_xor_b32 v10, s23, v31
  v_or3_b32 v11, v11, v9, v10
  v_and_b32 v11, 0xff, v11
  v_xor_b32 v9, s24, v28
  v_xor_b32 v10, s25, v29
  v_or_b32 v12, v9, v10
  v_xor_b32 v9, s26, v30
  v_xor_b32 v10, s27, v31
  v_or3_b32 v12, v12, v9, v10
  v_and_b32 v12, 0xff, v12
  v_min_u32 v11, v11, v12
  v_or_b32 v8, v8, v11
  v_xor_b32 v9, s20, v32
  v_xor_b32 v10, s21, v33
  v_or_b32 v11, v9, v10
  v_xor_b32 v9, s22, v34
  v_xor_b32 v10, s23, v35
  v_or3_b32 v11, v11, v9, v10
  v_and_b32 v11, 0xff, v11
  v_xor_b32 v9, s24, v32
  v_xor_b32 v10, s25, v33
  v_or_b32 v12, v9, v10
  v_xor_b32 v9, s26, v34
  v_xor_b32 v10, s27, v35
  v_or3_b32 v12, v12, v9, v10
  v_and_b32 v12, 0xff, v12
  v_min_u32 v11, v11, v12
  v_or_b32 v8, v8, v11
  v_xor_b32 v9, s20, v36
  v_xor_b32 v10, s21, v37
  v_or_b32 v11, v9, v10
  v_xor_b32 v9, s22, v38
  v_xor_b32 v10, s23, v39
  v_or3_b32 v11, v11, v9, v10
  v_and_b32 v11, 0xff, v11
  v_xor_b32 v9, s24, v36
  v_xor_b32 v10, s25, v37
  v_or_b32 v12, v9, v10
  v_xor_b32 v9, s26, v38
  v_xor_b32 v10, s27, v39
  v_or3_b32 v12, v12, v9, v10
  v_and_b32 v12, 0xff, v12
  v_min_u32 v11, v11, v12
  v_or_b32 v8, v8, v11
  v_xor_b32 v9, s20, v40
  v_xor_b32 v10, s21, v41
  v_or_b32 v11, v9, v10
  v_xor_b32 v9, s22, v42
  v_xor_b32 v10, s23, v43
  v_or3_b32 v11, v11, v9, v10
  v_and_b32 v11, 0xff, v11
  v_xor_b32 v9, s24, v40
  v_xor_b32 v10, s25, v41
  v_or_b32 v12, v9, v10
  v_xor_b32 v9, s26, v42
  v_xor_b32 v10, s27, v43
  v_or3_b32 v12, v12, v9, v10
  v_and_b32 v12, 0xff, v12
  v_min_u32 v11, v11, v12
  v_or_b32 v8, v8, v11
  v_xor_b32 v9, s20, v44
  v_xor_b32 v10, s21, v45
  v_or_b32 v11, v9, v10
  v_xor_b32 v9, s22, v46
  v_xor_b32 v10, s23, v47
  v_or3_b32 v11, v11, v9, v10
  v_and_b32 v11, 0xff, v11
  v_xor_b32 v9, s24, v44
  v_xor_b32 v10, s25, v45
  v_or_b32 v12, v9, v10
  v_xor_b32 v9, s26, v46
  v_xor_b32 v10, s27, v47
  v_or3_b32 v12, v12, v9, v10
  v_and_b32 v12, 0xff, v12
  v_min_u32 v11, v11, v12
  v_or_b32 v8, v8, v11
  v_cmp_ne_u32 vcc, 0, v8
  v_and_b32 v16, v3, v16
  v_and_b32 v17, v3, v17
  v_and_b32 v18, v3, v18
  v_and_b32 v19, v3, v19
  v_and_b32 v20, v3, v20
  v_and_b32 v21, v3, v21
  v_and_b32 v22, v3, v22
  v_and_b32 v23, v3, v23
  v_and_b32 v24, v3, v24
  v_and_b32 v25, v3, v25
  v_and_b32 v26, v3, v26
  v_and_b32 v27, v3, v27
  v_and_b32 v28, v3, v28
  v_and_b32 v29, v3, v29
  v_and_b32 v30, v3, v30
  v_and_b32 v31, v3, v31
  v_and_b32 v32, v3, v32
  v_and_b32 v33, v3, v33
  v_and_b32 v34, v3, v34
  v_and_b32 v35, v3, v35
  v_and_b32 v36, v3, v36
  v_and_b32 v37, v3, v37
  v_and_b32 v38, v3, v38
  v_and_b32 v39, v3, v39
  v_and_b32 v40, v3, v40
  v_and_b32 v41, v3, v41
  v_and_b32 v42, v3, v42
  v_and_b32 v43, v3, v43
  v_and_b32 v44, v3, v44
  v_and_b32 v45, v3, v45
  v_and_b32 v46, v3, v46
  v_and_b32 v47, v3, v47
  s_nop 1
  s_cbranch_vccz L_pok_4
  s_mov_b64 exec, vcc
  s_sleep 4
  s_add_u32 s79, s79, 1
  s_cmp_lt_u32 s79, 60000
  s_cbranch_scc1 L_sp_39
  s_branch L_pok_4
L_slow_15:
  s_mov_b64 s[44:45], exec
  s_mov_b64 exec, -1
  v_mov_b32 v9, 0
  v_mov_b32 v10, 2
  s_mov_b64 s[46:47], exec
  s_mov_b32 exec_lo, 0x1
  s_mov_b32 exec_hi, 0x0
  ds_max_u32 v9, v10 offset:1308
  s_mov_b64 exec, s[46:47]
  s_cmp_eq_u32 s40, 0
  s_cbranch_scc1 L_nr_40
  v_and_or_b32 v100, v100, v3, s24
  v_and_or_b32 v101, v101, v3, s25
  v_and_or_b32 v102, v102, v3, s26
  v_and_or_b32 v103, v103, v3, s27
  s_mov_b32 exec_lo, 0xff00ff
  s_mov_b32 exec_hi, 0xff00ff
  buffer_store_dwordx4 v[100:103], v104, s[16:19], s41 offen sc1
  s_mov_b64 exec, -1
  s_nop 0
L_nr_40:
  s_mov_b32 s42, 1
  s_mov_b64 exec, s[44:45]
  s_mov_b32 s79, 0
L_sp_41:
  buffer_load_dwordx4 v[16:19], v8, s[16:19], s82 offen sc1
  buffer_load_dwordx4 v[20:23], v8, s[16:19], s83 offen sc1
  buffer_load_dwordx4 v[24:27], v8, s[16:19], s84 offen sc1
  buffer_load_dwordx4 v[28:31], v8, s[16:19], s85 offen sc1
  s_waitcnt vmcnt(0)
  v_mov_b32 v9, 0
  v_xor_b32 v10, s20, v16
  v_xor_b32 v11, s21, v17
  v_or_b32 v12, v10, v11
  v_xor_b32 v10, s22, v18
  v_xor_b32 v11, s23, v19
  v_or3_b32 v12, v12, v10, v11
  v_and_b32 v12, 0xff, v12
  v_xor_b32 v10, s24, v16
  v_xor_b32 v11, s25, v17
  v_or_b32 v13, v10, v11
  v_xor_b32 v10, s26, v18
  v_xor_b32 v11, s27, v19
  v_or3_b32 v13, v13, v10, v11
  v_and_b32 v13, 0xff, v13
  v_min_u32 v12, v12, v13
  v_or_b32 v9, v9, v12
  v_xor_b32 v10, s20, v20
  v_xor_b32 v11, s21, v21
  v_or_b32 v12, v10, v11
  v_xor_b32 v10, s22, v22
  v_xor_b32 v11, s23, v23
  v_or3_b32 v12, v12, v10, v11
  v_and_b32 v12, 0xff, v12
  v_xor_b32 v10, s24, v20
  v_xor_b32 v11, s25, v21
  v_or_b32 v13, v10, v11
  v_xor_b32 v10, s26, v22
  v_xor_b32 v11, s27, v23
  v_or3_b32 v13, v13, v10, v11
  v_and_b32 v13, 0xff, v13
  v_min_u32 v12, v12, v13
  v_or_b32 v9, v9, v12
  v_xor_b32 v10, s20, v24
  v_xor_b32 v11, s21, v25
  v_or_b32 v12, v10, v11
  v_xor_b32 v10, s22, v26
  v_xor_b32 v11, s23, v27
  v_or3_b32 v12, v12, v10, v11
  v_and_b32 v12, 0xff, v12
  v_xor_b32 v10, s24, v24
  v_xor_b32 v11, s25, v25
  v_or_b32 v13, v10, v11
  v_xor_b32 v10, s26, v26
  v_xor_b32 v11, s27, v27
  v_or3_b32 v13, v13, v10, v11
  v_and_b32 v13, 0xff, v13
  v_min_u32 v12, v12, v13
  v_or_b32 v9, v9, v12
  v_xor_b32 v10, s20, v28
  v_xor_b32 v11, s21, v29
  v_or_b32 v12, v10, v11
  v_xor_b32 v10, s22, v30
  v_xor_b32 v11, s23, v31
  v_or3_b32 v12, v12, v10, v11
  v_and_b32 v12, 0xff, v12
  v_xor_b32 v10, s24, v28
  v_xor_b32 v11, s25, v29
  v_or_b32 v13, v10, v11
  v_xor_b32 v10, s26, v30
  v_xor_b32 v11, s27, v31
  v_or3_b32 v13, v13, v10, v11
  v_and_b32 v13, 0xff, v13
  v_min_u32 v12, v12, v13
  v_or_b32 v9, v9, v12
  v_cmp_ne_u32 vcc, 0, v9
  v_and_b32 v16, v3, v16
  v_and_b32 v17, v3, v17
  v_and_b32 v18, v3, v18
  v_and_b32 v19, v3, v19
  v_and_b32 v20, v3, v20
  v_and_b32 v21, v3, v21
  v_and_b32 v22, v3, v22
  v_and_b32 v23, v3, v23
  v_and_b32 v24, v3, v24
  v_and_b32 v25, v3, v25
  v_and_b32 v26, v3, v26
  v_and_b32 v27, v3, v27
  v_and_b32 v28, v3, v28
  v_and_b32 v29, v3, v29
  v_and_b32 v30, v3, v30
  v_and_b32 v31, v3, v31
  s_nop 1
  s_cbranch_vccz L_pok_13
  s_mov_b64 exec, vcc
  s_sleep 4
  s_add_u32 s79, s79, 1
  s_cmp_lt_u32 s79, 60000
  s_cbranch_scc1 L_sp_41
  s_branch L_pok_13
L_slow_28:
  s_mov_b64 s[44:45], exec
  s_mov_b64 exec, -1
  v_mov_b32 v5, 0
  v_mov_b32 v6, 2
  s_mov_b64 s[46:47], exec
  s_mov_b32 exec_lo, 0x1
  s_mov_b32 exec_hi, 0x0
  ds_max_u32 v5, v6 offset:1308
  s_mov_b64 exec, s[46:47]
  s_mov_b32 s42, 1
  s_mov_b64 exec, s[44:45]
  s_mov_b32 s79, 0
L_sp_42:
  buffer_load_dwordx4 v[104:107], v9, s[16:19], s82 offen sc1
  buffer_load_dwordx4 v[108:111], v9, s[16:19], s83 offen sc1
  s_waitcnt vmcnt(0)
  v_mov_b32 v5, 0
  v_xor_b32 v6, s20, v104
  v_xor_b32 v7, s21, v105
  v_or_b32 v10, v6, v7
  v_xor_b32 v6, s22, v106
  v_xor_b32 v7, s23, v107
  v_or3_b32 v10, v10, v6, v7
  v_and_b32 v10, 0xff, v10
  v_xor_b32 v6, s24, v104
  v_xor_b32 v7, s25, v105
  v_or_b32 v11, v6, v7
  v_xor_b32 v6, s26, v106
  v_xor_b32 v7, s27, v107
  v_or3_b32 v11, v11, v6, v7
  v_and_b32 v11, 0xff, v11
  v_min_u32 v10, v10, v11
  v_or_b32 v5, v5, v10
  v_xor_b32 v6, s20, v108
  v_xor_b32 v7, s21, v109
  v_or_b32 v10, v6, v7
  v_xor_b32 v6, s22, v110
  v_xor_b32 v7, s23, v111
  v_or3_b32 v10, v10, v6, v7
  v_and_b32 v10, 0xff, v10
  v_xor_b32 v6, s24, v108
  v_xor_b32 v7, s25, v109
  v_or_b32 v11, v6, v7
  v_xor_b32 v6, s26, v110
  v_xor_b32 v7, s27, v111
  v_or3_b32 v11, v11, v6, v7
  v_and_b32 v11, 0xff, v11
  v_min_u32 v10, v10, v11
  v_or_b32 v5, v5, v10
  v_cmp_ne_u32 vcc, 0, v5
  v_and_b32 v104, v3, v104
  v_and_b32 v105, v3, v105
  v_and_b32 v106, v3, v106
  v_and_b32 v107, v3, v107
  v_and_b32 v108, v3, v108
  v_and_b32 v109, v3, v109
  v_and_b32 v110, v3, v110
  v_and_b32 v111, v3, v111
  s_nop 1
  s_cbranch_vccz L_pok_26
  s_mov_b64 exec, vcc
  s_sleep 4
  s_add_u32 s79, s79, 1
  s_cmp_lt_u32 s79, 60000
  s_cbranch_scc1 L_sp_42
  s_branch L_pok_26
L_fin:
L_end:
  s_endpgm
.section .rodata,"a"
.p2align 6
.amdhsa_kernel gated_mix__sliding_block_cached__swiglu_ffn__decode_kernel
  .amdhsa_next_free_vgpr 128
  .amdhsa_next_free_sgpr 102
  .amdhsa_accum_offset 128
  .amdhsa_group_segment_fixed_size 0
  .amdhsa_kernarg_size 104
  .amdhsa_user_sgpr_count 2
  .amdhsa_user_sgpr_kernarg_segment_ptr 1
  .amdhsa_system_sgpr_workgroup_id_x 1
.end_amdhsa_kernel
```
